```python
import torch

def _softmax(x, axis=-1):
    return torch.softmax(x, dim=axis)
def _gelu(x):
    return torch.nn.functional.gelu(x, approximate="tanh")
def _silu(x):
    return torch.nn.functional.silu(x)
def _sigmoid(x):
    return torch.sigmoid(x)
def _layernorm(x, axis=-1, eps=1e-5):
    m = x.mean(dim=axis, keepdim=True)
    v = x.var(dim=axis, keepdim=True, unbiased=False)
    return (x - m) / torch.sqrt(v + eps)
def _scatter_add(tgt, idx, src, axis=0):
    return tgt.clone().index_add_(axis, idx, src)
def _segment_sum(src, seg, n):
    out = torch.zeros((n,) + src.shape[1:], dtype=src.dtype)
    return out.index_add_(0, seg, src)
def _pad(x, pw):
    flat = tuple(v for pair in reversed(pw) for v in pair)
    return torch.nn.functional.pad(x, flat)

kernel_name = 'recurrent_scan__mha_block_cached__swiglu_ffn__decode'

def setup_inputs():

    _w = (lambda a: (lambda t: t.to(torch.bfloat16) if t.is_floating_point() else t)(torch.as_tensor(a)))
    def _A_setup():
        B, Sq, D = 1, 1, 512
        H, Sk, Dh = 32, 32768, 128
        return {
            "x": _w((lambda *s: torch.randn(*s, dtype=torch.bfloat16) * 0.05)(B, Sq, D)),
            "k_cache": _w((lambda *s: torch.randn(*s, dtype=torch.bfloat16) * 0.8)(B, H, Sk, Dh)),
            "v_cache": _w((lambda *s: torch.randn(*s, dtype=torch.bfloat16) * 0.8)(B, H, Sk, Dh)),
            "wq": _w((lambda *s: torch.randn(*s, dtype=torch.bfloat16) * 0.8)(D, H * Dh) * (D ** -0.5)),
            "wo": _w((lambda *s: torch.randn(*s, dtype=torch.bfloat16) * 0.8)(H * Dh, D) * ((H * Dh) ** -0.5)),
        }
    _A_in = _A_setup()

    def _B_setup():
        B, S, D, F = 1, 1, 512, 1376
        return {
            "x": _w((lambda *s: torch.randn(*s, dtype=torch.bfloat16) * 0.05)(B, S, D)),
            "w_gate": _w((lambda *s: torch.randn(*s, dtype=torch.bfloat16) * 0.2)(D, F)),
            "w_up": _w((lambda *s: torch.randn(*s, dtype=torch.bfloat16) * 0.2)(D, F)),
            "w_down": _w((lambda *s: torch.randn(*s, dtype=torch.bfloat16) * 0.2)(F, D)),
        }
    _B_in = _B_setup()

    return {
        "A_x": _A_in["x"],
        "A_k_cache": _A_in["k_cache"],
        "A_v_cache": _A_in["v_cache"],
        "A_wq": _A_in["wq"],
        "A_wo": _A_in["wo"],
        "B_x": _B_in["x"],
        "B_w_gate": _B_in["w_gate"],
        "B_w_up": _B_in["w_up"],
        "B_w_down": _B_in["w_down"],
    }

def reference(A_x, A_k_cache, A_v_cache, A_wq, A_wo, B_x, B_w_gate, B_w_up, B_w_down):
    def _A_ref(x, k_cache, v_cache, wq, wo):
        B, Sq, D = x.shape
        H, Dh = 32, 128
        q = (lambda x, *d: x.permute(*d))((x @ wq).reshape(B, Sq, H, Dh), 0, 2, 1, 3)
        scores = torch.einsum("bhqd,bhkd->bhqk", q, k_cache) * (Dh ** -0.5)
        p = _softmax(scores, axis=-1)
        o = torch.einsum("bhqk,bhkd->bhqd", p, v_cache)
        return (lambda x, *d: x.permute(*d))(o, 0, 2, 1, 3).reshape(B, Sq, H * Dh) @ wo

    def _B_ref(x, w_gate, w_up, w_down):
        g = _silu(x @ w_gate)
        u = x @ w_up
        return (g * u) @ w_down

    x = A_x
    xn = _layernorm(x, axis=-1)
    s = _A_ref(xn, A_k_cache, A_v_cache, A_wq, A_wo)
    g = _silu(_B_ref(xn, B_w_gate, B_w_up, B_w_down))
    return x + s * g
```

```asm
; @launch grid=(256,1,1) block=(320,1,1) lds=26624
.amdgcn_target "amdgcn-amd-amdhsa--gfx950"
.text
.globl recurrent_scan__mha_block_cached__swiglu_ffn__decode_kernel
.p2align 8
.type recurrent_scan__mha_block_cached__swiglu_ffn__decode_kernel,@function
recurrent_scan__mha_block_cached__swiglu_ffn__decode_kernel:
    s_cmp_ge_u32 s2, 256
    s_cbranch_scc1 L_end
    v_lshrrev_b32 v1, 6, v0
    v_and_b32 v0, 63, v0
    s_load_dwordx2 s[24:25], s[0:1], 88
    v_readfirstlane_b32 s20, v1
    s_lshr_b32 s21, s2, 3
    s_and_b32 s22, s2, 7
    s_cmp_eq_u32 s20, 0
    s_cbranch_scc1 L_helper
    s_load_dwordx4 s[4:7], s[0:1], 8
    s_setprio 1
    s_sub_u32 s23, s20, 1
    v_and_b32 v20, 15, v0
    v_lshrrev_b32 v21, 4, v0
    v_and_b32 v22, 3, v20
    v_and_b32 v23, 1, v22
    v_lshlrev_b32 v23, 10, v23
    v_lshrrev_b32 v24, 1, v22
    v_lshl_add_u32 v23, v24, 15, v23
    v_lshrrev_b32 v22, 2, v20
    v_and_b32 v25, 1, v22
    v_lshlrev_b32 v25, 8, v25
    v_lshrrev_b32 v24, 1, v22
    v_lshl_add_u32 v25, v24, 9, v25
    v_add_u32 v23, v23, v25
    v_lshl_add_u32 v2, v21, 4, v23
    v_and_b32 v23, 1, v21
    v_lshlrev_b32 v23, 8, v23
    v_lshrrev_b32 v24, 1, v21
    v_lshl_add_u32 v23, v24, 9, v23
    v_lshl_add_u32 v3, v20, 4, v23
    v_add_u32 v61, 1024, v3
    v_add_u32 v62, 32768, v3
    v_add_u32 v63, 33792, v3
    v_and_b32 v22, 1, v20
    v_mov_b32 v23, 0xffff
    v_mov_b32 v24, 0xffff0000
    v_cmp_eq_u32 vcc, 1, v22
    v_lshrrev_b32 v25, 1, v20
    s_nop 0
    v_cndmask_b32 v23, v23, v24, vcc
    v_cmp_eq_u32 vcc, 0, v25
    s_nop 1
    v_cndmask_b32 v6, 0, v23, vcc
    v_cmp_eq_u32 vcc, 1, v25
    s_nop 1
    v_cndmask_b32 v7, 0, v23, vcc
    v_cmp_eq_u32 vcc, 2, v25
    s_nop 1
    v_cndmask_b32 v8, 0, v23, vcc
    v_cmp_eq_u32 vcc, 3, v25
    s_nop 1
    v_cndmask_b32 v9, 0, v23, vcc
    v_mov_b32 v10, 0xff800000
    v_mov_b32 v11, 0
    v_mov_b32 v12, 0
    v_mov_b32 v13, 0
    v_mov_b32 v14, 0
    v_mov_b32 v15, 0
    s_mov_b32 s30, 0x3e0293ee
    s_mov_b32 s31, 0xbe0293ee
    s_lshl_b32 s26, s21, 23
    s_and_b32 s29, s23, 1
    s_lshl_b32 s29, s29, 12
    s_add_u32 s26, s26, s29
    s_lshr_b32 s29, s23, 1
    s_lshl_b32 s29, s29, 13
    s_add_u32 s26, s26, s29
    s_lshl_b32 s27, s22, 2
    s_add_u32 s27, s27, s23
    s_waitcnt lgkmcnt(0)
    s_mov_b32 s8, s4
    s_mov_b32 s9, s5
    s_mov_b32 s10, 0x10000000
    s_mov_b32 s11, 0x20000
    s_mov_b32 s12, s6
    s_mov_b32 s13, s7
    s_mov_b32 s14, 0x10000000
    s_mov_b32 s15, 0x20000
    s_barrier
    s_add_u32 s29, s27, 0
    s_bfe_u32 s38, s29, 0x10002
    s_lshl_b32 s38, s38, 11
    s_bfe_u32 s33, s29, 0x10003
    s_lshl_b32 s33, s33, 14
    s_add_u32 s38, s38, s33
    s_bfe_u32 s33, s29, 0x70004
    s_lshl_b32 s33, s33, 16
    s_add_u32 s38, s38, s33
    s_mov_b32 s29, s38
    s_lshr_b32 s33, s29, 7
    s_and_b32 s33, s33, 0x800
    s_xor_b32 s29, s29, s33
    s_lshr_b32 s33, s29, 5
    s_and_b32 s33, s33, 0x4000
    s_xor_b32 s29, s29, s33
    s_lshr_b32 s33, s29, 8
    s_and_b32 s33, s33, 0x3000
    s_xor_b32 s29, s29, s33
    s_xor_b32 s40, s29, s26
    buffer_load_dwordx4 v[64:67], v2, s[8:11], s40 offen offset:0 nt
    buffer_load_dwordx4 v[68:71], v2, s[8:11], s40 offen offset:64 nt
    buffer_load_dwordx4 v[72:75], v2, s[8:11], s40 offen offset:128 nt
    buffer_load_dwordx4 v[76:79], v2, s[8:11], s40 offen offset:192 nt
    buffer_load_dwordx4 v[80:83], v3, s[12:15], s40 offen offset:0 nt
    buffer_load_dwordx4 v[84:87], v61, s[12:15], s40 offen offset:0 nt
    buffer_load_dwordx4 v[88:91], v62, s[12:15], s40 offen offset:0 nt
    buffer_load_dwordx4 v[92:95], v63, s[12:15], s40 offen offset:0 nt
    s_waitcnt vmcnt(4)
    s_add_u32 s29, s27, 32
    s_bfe_u32 s38, s29, 0x10002
    s_lshl_b32 s38, s38, 11
    s_bfe_u32 s33, s29, 0x10003
    s_lshl_b32 s33, s33, 14
    s_add_u32 s38, s38, s33
    s_bfe_u32 s33, s29, 0x70004
    s_lshl_b32 s33, s33, 16
    s_add_u32 s38, s38, s33
    s_mov_b32 s29, s38
    s_lshr_b32 s33, s29, 7
    s_and_b32 s33, s33, 0x800
    s_xor_b32 s29, s29, s33
    s_lshr_b32 s33, s29, 5
    s_and_b32 s33, s33, 0x4000
    s_xor_b32 s29, s29, s33
    s_lshr_b32 s33, s29, 8
    s_and_b32 s33, s33, 0x3000
    s_xor_b32 s29, s29, s33
    s_xor_b32 s41, s29, s26
    buffer_load_dwordx4 v[96:99], v2, s[8:11], s41 offen offset:0 nt
    buffer_load_dwordx4 v[100:103], v2, s[8:11], s41 offen offset:64 nt
    buffer_load_dwordx4 v[104:107], v2, s[8:11], s41 offen offset:128 nt
    buffer_load_dwordx4 v[108:111], v2, s[8:11], s41 offen offset:192 nt
    s_waitcnt vmcnt(4)
    buffer_load_dwordx4 v[112:115], v3, s[12:15], s41 offen offset:0 nt
    buffer_load_dwordx4 v[116:119], v61, s[12:15], s41 offen offset:0 nt
    buffer_load_dwordx4 v[120:123], v62, s[12:15], s41 offen offset:0 nt
    buffer_load_dwordx4 v[124:127], v63, s[12:15], s41 offen offset:0 nt
    s_waitcnt vmcnt(4)
    s_add_u32 s29, s27, 64
    s_bfe_u32 s38, s29, 0x10002
    s_lshl_b32 s38, s38, 11
    s_bfe_u32 s33, s29, 0x10003
    s_lshl_b32 s33, s33, 14
    s_add_u32 s38, s38, s33
    s_bfe_u32 s33, s29, 0x70004
    s_lshl_b32 s33, s33, 16
    s_add_u32 s38, s38, s33
    s_mov_b32 s29, s38
    s_lshr_b32 s33, s29, 7
    s_and_b32 s33, s33, 0x800
    s_xor_b32 s29, s29, s33
    s_lshr_b32 s33, s29, 5
    s_and_b32 s33, s33, 0x4000
    s_xor_b32 s29, s29, s33
    s_lshr_b32 s33, s29, 8
    s_and_b32 s33, s33, 0x3000
    s_xor_b32 s29, s29, s33
    s_xor_b32 s42, s29, s26
    buffer_load_dwordx4 v[128:131], v2, s[8:11], s42 offen offset:0 nt
    buffer_load_dwordx4 v[132:135], v2, s[8:11], s42 offen offset:64 nt
    buffer_load_dwordx4 v[136:139], v2, s[8:11], s42 offen offset:128 nt
    buffer_load_dwordx4 v[140:143], v2, s[8:11], s42 offen offset:192 nt
    s_waitcnt vmcnt(4)
    buffer_load_dwordx4 v[144:147], v3, s[12:15], s42 offen offset:0 nt
    buffer_load_dwordx4 v[148:151], v61, s[12:15], s42 offen offset:0 nt
    buffer_load_dwordx4 v[152:155], v62, s[12:15], s42 offen offset:0 nt
    buffer_load_dwordx4 v[156:159], v63, s[12:15], s42 offen offset:0 nt
    s_waitcnt vmcnt(4)
    s_add_u32 s29, s27, 96
    s_bfe_u32 s38, s29, 0x10002
    s_lshl_b32 s38, s38, 11
    s_bfe_u32 s33, s29, 0x10003
    s_lshl_b32 s33, s33, 14
    s_add_u32 s38, s38, s33
    s_bfe_u32 s33, s29, 0x70004
    s_lshl_b32 s33, s33, 16
    s_add_u32 s38, s38, s33
    s_mov_b32 s29, s38
    s_lshr_b32 s33, s29, 7
    s_and_b32 s33, s33, 0x800
    s_xor_b32 s29, s29, s33
    s_lshr_b32 s33, s29, 5
    s_and_b32 s33, s33, 0x4000
    s_xor_b32 s29, s29, s33
    s_lshr_b32 s33, s29, 8
    s_and_b32 s33, s33, 0x3000
    s_xor_b32 s29, s29, s33
    s_xor_b32 s43, s29, s26
    buffer_load_dwordx4 v[160:163], v2, s[8:11], s43 offen offset:0 nt
    buffer_load_dwordx4 v[164:167], v2, s[8:11], s43 offen offset:64 nt
    buffer_load_dwordx4 v[168:171], v2, s[8:11], s43 offen offset:128 nt
    buffer_load_dwordx4 v[172:175], v2, s[8:11], s43 offen offset:192 nt
    s_waitcnt vmcnt(4)
    buffer_load_dwordx4 v[176:179], v3, s[12:15], s43 offen offset:0 nt
    buffer_load_dwordx4 v[180:183], v61, s[12:15], s43 offen offset:0 nt
    buffer_load_dwordx4 v[184:187], v62, s[12:15], s43 offen offset:0 nt
    buffer_load_dwordx4 v[188:191], v63, s[12:15], s43 offen offset:0 nt
    s_waitcnt vmcnt(4)
    s_add_u32 s29, s27, 128
    s_bfe_u32 s38, s29, 0x10002
    s_lshl_b32 s38, s38, 11
    s_bfe_u32 s33, s29, 0x10003
    s_lshl_b32 s33, s33, 14
    s_add_u32 s38, s38, s33
    s_bfe_u32 s33, s29, 0x70004
    s_lshl_b32 s33, s33, 16
    s_add_u32 s38, s38, s33
    s_mov_b32 s29, s38
    s_lshr_b32 s33, s29, 7
    s_and_b32 s33, s33, 0x800
    s_xor_b32 s29, s29, s33
    s_lshr_b32 s33, s29, 5
    s_and_b32 s33, s33, 0x4000
    s_xor_b32 s29, s29, s33
    s_lshr_b32 s33, s29, 8
    s_and_b32 s33, s33, 0x3000
    s_xor_b32 s29, s29, s33
    s_xor_b32 s44, s29, s26
    buffer_load_dwordx4 v[192:195], v2, s[8:11], s44 offen offset:0 nt
    buffer_load_dwordx4 v[196:199], v2, s[8:11], s44 offen offset:64 nt
    buffer_load_dwordx4 v[200:203], v2, s[8:11], s44 offen offset:128 nt
    buffer_load_dwordx4 v[204:207], v2, s[8:11], s44 offen offset:192 nt
    s_waitcnt vmcnt(4)
    buffer_load_dwordx4 v[208:211], v3, s[12:15], s44 offen offset:0 nt
    buffer_load_dwordx4 v[212:215], v61, s[12:15], s44 offen offset:0 nt
    buffer_load_dwordx4 v[216:219], v62, s[12:15], s44 offen offset:0 nt
    buffer_load_dwordx4 v[220:223], v63, s[12:15], s44 offen offset:0 nt
    s_waitcnt vmcnt(4)
    s_add_u32 s29, s27, 160
    s_bfe_u32 s38, s29, 0x10002
    s_lshl_b32 s38, s38, 11
    s_bfe_u32 s33, s29, 0x10003
    s_lshl_b32 s33, s33, 14
    s_add_u32 s38, s38, s33
    s_bfe_u32 s33, s29, 0x70004
    s_lshl_b32 s33, s33, 16
    s_add_u32 s38, s38, s33
    s_mov_b32 s29, s38
    s_lshr_b32 s33, s29, 7
    s_and_b32 s33, s33, 0x800
    s_xor_b32 s29, s29, s33
    s_lshr_b32 s33, s29, 5
    s_and_b32 s33, s33, 0x4000
    s_xor_b32 s29, s29, s33
    s_lshr_b32 s33, s29, 8
    s_and_b32 s33, s33, 0x3000
    s_xor_b32 s29, s29, s33
    s_xor_b32 s45, s29, s26
    buffer_load_dwordx4 v[224:227], v2, s[8:11], s45 offen offset:0 nt
    buffer_load_dwordx4 v[228:231], v2, s[8:11], s45 offen offset:64 nt
    buffer_load_dwordx4 v[232:235], v2, s[8:11], s45 offen offset:128 nt
    buffer_load_dwordx4 v[236:239], v2, s[8:11], s45 offen offset:192 nt
    s_waitcnt vmcnt(4)
    buffer_load_dwordx4 v[240:243], v3, s[12:15], s45 offen offset:0 nt
    buffer_load_dwordx4 v[244:247], v61, s[12:15], s45 offen offset:0 nt
    buffer_load_dwordx4 v[248:251], v62, s[12:15], s45 offen offset:0 nt
    buffer_load_dwordx4 v[252:255], v63, s[12:15], s45 offen offset:0 nt
    s_barrier
    v_lshrrev_b32 v20, 4, v0
    v_lshlrev_b32 v20, 4, v20
    ds_read_b128 v[44:47], v20 offset:2048
    ds_read_b128 v[48:51], v20 offset:2112
    ds_read_b128 v[52:55], v20 offset:2176
    ds_read_b128 v[56:59], v20 offset:2240
    s_waitcnt lgkmcnt(0)
    v_mfma_f32_16x16x32_bf16 v[16:19], v[64:67], v[44:47], 0
    v_mfma_f32_16x16x32_bf16 v[16:19], v[68:71], v[48:51], v[16:19]
    v_mfma_f32_16x16x32_bf16 v[16:19], v[72:75], v[52:55], v[16:19]
    v_mfma_f32_16x16x32_bf16 v[16:19], v[76:79], v[56:59], v[16:19]
    s_nop 7
    v_max3_f32 v20, v16, v17, v18
    v_max_f32 v20, v20, v19
    v_mov_b32 v21, v20
    s_nop 1
    v_permlane16_swap_b32 v20, v21
    v_max_f32 v20, v20, v21
    v_mov_b32 v21, v20
    s_nop 1
    v_permlane32_swap_b32 v20, v21
    v_max3_f32 v20, v20, v21, v10
    v_mul_f32 v22, s31, v20
    v_fma_f32 v23, v10, s30, v22
    v_fma_f32 v24, v16, s30, v22
    v_fma_f32 v25, v17, s30, v22
    v_fma_f32 v26, v18, s30, v22
    v_fma_f32 v27, v19, s30, v22
    v_exp_f32 v23, v23
    v_exp_f32 v24, v24
    v_exp_f32 v25, v25
    v_exp_f32 v26, v26
    v_exp_f32 v27, v27
    v_mov_b32 v10, v20
    v_mul_f32 v12, v12, v23
    v_mul_f32 v13, v13, v23
    v_mul_f32 v14, v14, v23
    v_mul_f32 v15, v15, v23
    v_add_f32 v20, v24, v25
    v_add_f32 v21, v26, v27
    v_cvt_pk_bf16_f32 v24, v24, v24
    v_cvt_pk_bf16_f32 v25, v25, v25
    v_cvt_pk_bf16_f32 v26, v26, v26
    v_cvt_pk_bf16_f32 v27, v27, v27
    v_add_f32 v20, v20, v21
    v_fma_f32 v11, v11, v23, v20
    v_and_b32 v28, v24, v6
    v_and_b32 v29, v24, v7
    v_and_b32 v30, v24, v8
    v_and_b32 v31, v24, v9
    v_and_b32 v32, v25, v6
    v_and_b32 v33, v25, v7
    v_and_b32 v34, v25, v8
    v_and_b32 v35, v25, v9
    v_and_b32 v36, v26, v6
    v_and_b32 v37, v26, v7
    v_and_b32 v38, v26, v8
    v_and_b32 v39, v26, v9
    v_and_b32 v40, v27, v6
    v_and_b32 v41, v27, v7
    v_and_b32 v42, v27, v8
    v_and_b32 v43, v27, v9
    s_waitcnt vmcnt(4)
    s_add_u32 s29, s27, 192
    s_bfe_u32 s38, s29, 0x10002
    s_lshl_b32 s38, s38, 11
    s_bfe_u32 s33, s29, 0x10003
    s_lshl_b32 s33, s33, 14
    s_add_u32 s38, s38, s33
    s_bfe_u32 s33, s29, 0x70004
    s_lshl_b32 s33, s33, 16
    s_add_u32 s38, s38, s33
    s_mov_b32 s29, s38
    s_lshr_b32 s33, s29, 7
    s_and_b32 s33, s33, 0x800
    s_xor_b32 s29, s29, s33
    s_lshr_b32 s33, s29, 5
    s_and_b32 s33, s33, 0x4000
    s_xor_b32 s29, s29, s33
    s_lshr_b32 s33, s29, 8
    s_and_b32 s33, s33, 0x3000
    s_xor_b32 s29, s29, s33
    s_xor_b32 s40, s29, s26
    buffer_load_dwordx4 v[64:67], v2, s[8:11], s40 offen offset:0 nt
    buffer_load_dwordx4 v[68:71], v2, s[8:11], s40 offen offset:64 nt
    buffer_load_dwordx4 v[72:75], v2, s[8:11], s40 offen offset:128 nt
    buffer_load_dwordx4 v[76:79], v2, s[8:11], s40 offen offset:192 nt
    s_nop 1
    v_mfma_f32_16x16x32_bf16 v[12:15], v[28:31], v[80:83], v[12:15]
    v_mfma_f32_16x16x32_bf16 v[12:15], v[32:35], v[84:87], v[12:15]
    v_mfma_f32_16x16x32_bf16 v[12:15], v[36:39], v[88:91], v[12:15]
    v_mfma_f32_16x16x32_bf16 v[12:15], v[40:43], v[92:95], v[12:15]
    v_mfma_f32_16x16x32_bf16 v[16:19], v[96:99], v[44:47], 0
    v_mfma_f32_16x16x32_bf16 v[16:19], v[100:103], v[48:51], v[16:19]
    v_mfma_f32_16x16x32_bf16 v[16:19], v[104:107], v[52:55], v[16:19]
    v_mfma_f32_16x16x32_bf16 v[16:19], v[108:111], v[56:59], v[16:19]
    s_nop 7
    v_max3_f32 v20, v16, v17, v18
    v_max_f32 v20, v20, v19
    v_mov_b32 v21, v20
    s_nop 1
    v_permlane16_swap_b32 v20, v21
    v_max_f32 v20, v20, v21
    v_mov_b32 v21, v20
    s_nop 1
    v_permlane32_swap_b32 v20, v21
    v_max3_f32 v20, v20, v21, v10
    v_mul_f32 v22, s31, v20
    v_fma_f32 v23, v10, s30, v22
    v_fma_f32 v24, v16, s30, v22
    v_fma_f32 v25, v17, s30, v22
    v_fma_f32 v26, v18, s30, v22
    v_fma_f32 v27, v19, s30, v22
    v_exp_f32 v23, v23
    v_exp_f32 v24, v24
    v_exp_f32 v25, v25
    v_exp_f32 v26, v26
    v_exp_f32 v27, v27
    v_mov_b32 v10, v20
    v_mul_f32 v12, v12, v23
    v_mul_f32 v13, v13, v23
    v_mul_f32 v14, v14, v23
    v_mul_f32 v15, v15, v23
    v_add_f32 v20, v24, v25
    v_add_f32 v21, v26, v27
    v_cvt_pk_bf16_f32 v24, v24, v24
    v_cvt_pk_bf16_f32 v25, v25, v25
    v_cvt_pk_bf16_f32 v26, v26, v26
    v_cvt_pk_bf16_f32 v27, v27, v27
    v_add_f32 v20, v20, v21
    v_fma_f32 v11, v11, v23, v20
    v_and_b32 v28, v24, v6
    v_and_b32 v29, v24, v7
    v_and_b32 v30, v24, v8
    v_and_b32 v31, v24, v9
    v_and_b32 v32, v25, v6
    v_and_b32 v33, v25, v7
    v_and_b32 v34, v25, v8
    v_and_b32 v35, v25, v9
    v_and_b32 v36, v26, v6
    v_and_b32 v37, v26, v7
    v_and_b32 v38, v26, v8
    v_and_b32 v39, v26, v9
    v_and_b32 v40, v27, v6
    v_and_b32 v41, v27, v7
    v_and_b32 v42, v27, v8
    v_and_b32 v43, v27, v9
    s_waitcnt vmcnt(4)
    buffer_load_dwordx4 v[80:83], v3, s[12:15], s40 offen offset:0 nt
    buffer_load_dwordx4 v[84:87], v61, s[12:15], s40 offen offset:0 nt
    buffer_load_dwordx4 v[88:91], v62, s[12:15], s40 offen offset:0 nt
    buffer_load_dwordx4 v[92:95], v63, s[12:15], s40 offen offset:0 nt
    s_nop 1
    v_mfma_f32_16x16x32_bf16 v[12:15], v[28:31], v[112:115], v[12:15]
    v_mfma_f32_16x16x32_bf16 v[12:15], v[32:35], v[116:119], v[12:15]
    v_mfma_f32_16x16x32_bf16 v[12:15], v[36:39], v[120:123], v[12:15]
    v_mfma_f32_16x16x32_bf16 v[12:15], v[40:43], v[124:127], v[12:15]
    v_mfma_f32_16x16x32_bf16 v[16:19], v[128:131], v[44:47], 0
    v_mfma_f32_16x16x32_bf16 v[16:19], v[132:135], v[48:51], v[16:19]
    v_mfma_f32_16x16x32_bf16 v[16:19], v[136:139], v[52:55], v[16:19]
    v_mfma_f32_16x16x32_bf16 v[16:19], v[140:143], v[56:59], v[16:19]
    s_nop 7
    v_max3_f32 v20, v16, v17, v18
    v_max_f32 v20, v20, v19
    v_mov_b32 v21, v20
    s_nop 1
    v_permlane16_swap_b32 v20, v21
    v_max_f32 v20, v20, v21
    v_mov_b32 v21, v20
    s_nop 1
    v_permlane32_swap_b32 v20, v21
    v_max3_f32 v20, v20, v21, v10
    v_mul_f32 v22, s31, v20
    v_fma_f32 v23, v10, s30, v22
    v_fma_f32 v24, v16, s30, v22
    v_fma_f32 v25, v17, s30, v22
    v_fma_f32 v26, v18, s30, v22
    v_fma_f32 v27, v19, s30, v22
    v_exp_f32 v23, v23
    v_exp_f32 v24, v24
    v_exp_f32 v25, v25
    v_exp_f32 v26, v26
    v_exp_f32 v27, v27
    v_mov_b32 v10, v20
    v_mul_f32 v12, v12, v23
    v_mul_f32 v13, v13, v23
    v_mul_f32 v14, v14, v23
    v_mul_f32 v15, v15, v23
    v_add_f32 v20, v24, v25
    v_add_f32 v21, v26, v27
    v_cvt_pk_bf16_f32 v24, v24, v24
    v_cvt_pk_bf16_f32 v25, v25, v25
    v_cvt_pk_bf16_f32 v26, v26, v26
    v_cvt_pk_bf16_f32 v27, v27, v27
    v_add_f32 v20, v20, v21
    v_fma_f32 v11, v11, v23, v20
    v_and_b32 v28, v24, v6
    v_and_b32 v29, v24, v7
    v_and_b32 v30, v24, v8
    v_and_b32 v31, v24, v9
    v_and_b32 v32, v25, v6
    v_and_b32 v33, v25, v7
    v_and_b32 v34, v25, v8
    v_and_b32 v35, v25, v9
    v_and_b32 v36, v26, v6
    v_and_b32 v37, v26, v7
    v_and_b32 v38, v26, v8
    v_and_b32 v39, v26, v9
    v_and_b32 v40, v27, v6
    v_and_b32 v41, v27, v7
    v_and_b32 v42, v27, v8
    v_and_b32 v43, v27, v9
    s_waitcnt vmcnt(4)
    s_add_u32 s29, s27, 224
    s_bfe_u32 s38, s29, 0x10002
    s_lshl_b32 s38, s38, 11
    s_bfe_u32 s33, s29, 0x10003
    s_lshl_b32 s33, s33, 14
    s_add_u32 s38, s38, s33
    s_bfe_u32 s33, s29, 0x70004
    s_lshl_b32 s33, s33, 16
    s_add_u32 s38, s38, s33
    s_mov_b32 s29, s38
    s_lshr_b32 s33, s29, 7
    s_and_b32 s33, s33, 0x800
    s_xor_b32 s29, s29, s33
    s_lshr_b32 s33, s29, 5
    s_and_b32 s33, s33, 0x4000
    s_xor_b32 s29, s29, s33
    s_lshr_b32 s33, s29, 8
    s_and_b32 s33, s33, 0x3000
    s_xor_b32 s29, s29, s33
    s_xor_b32 s41, s29, s26
    buffer_load_dwordx4 v[96:99], v2, s[8:11], s41 offen offset:0 nt
    buffer_load_dwordx4 v[100:103], v2, s[8:11], s41 offen offset:64 nt
    buffer_load_dwordx4 v[104:107], v2, s[8:11], s41 offen offset:128 nt
    buffer_load_dwordx4 v[108:111], v2, s[8:11], s41 offen offset:192 nt
    s_nop 1
    v_mfma_f32_16x16x32_bf16 v[12:15], v[28:31], v[144:147], v[12:15]
    v_mfma_f32_16x16x32_bf16 v[12:15], v[32:35], v[148:151], v[12:15]
    v_mfma_f32_16x16x32_bf16 v[12:15], v[36:39], v[152:155], v[12:15]
    v_mfma_f32_16x16x32_bf16 v[12:15], v[40:43], v[156:159], v[12:15]
    v_mfma_f32_16x16x32_bf16 v[16:19], v[160:163], v[44:47], 0
    v_mfma_f32_16x16x32_bf16 v[16:19], v[164:167], v[48:51], v[16:19]
    v_mfma_f32_16x16x32_bf16 v[16:19], v[168:171], v[52:55], v[16:19]
    v_mfma_f32_16x16x32_bf16 v[16:19], v[172:175], v[56:59], v[16:19]
    s_nop 7
    v_max3_f32 v20, v16, v17, v18
    v_max_f32 v20, v20, v19
    v_mov_b32 v21, v20
    s_nop 1
    v_permlane16_swap_b32 v20, v21
    v_max_f32 v20, v20, v21
    v_mov_b32 v21, v20
    s_nop 1
    v_permlane32_swap_b32 v20, v21
    v_max3_f32 v20, v20, v21, v10
    v_mul_f32 v22, s31, v20
    v_fma_f32 v23, v10, s30, v22
    v_fma_f32 v24, v16, s30, v22
    v_fma_f32 v25, v17, s30, v22
    v_fma_f32 v26, v18, s30, v22
    v_fma_f32 v27, v19, s30, v22
    v_exp_f32 v23, v23
    v_exp_f32 v24, v24
    v_exp_f32 v25, v25
    v_exp_f32 v26, v26
    v_exp_f32 v27, v27
    v_mov_b32 v10, v20
    v_mul_f32 v12, v12, v23
    v_mul_f32 v13, v13, v23
    v_mul_f32 v14, v14, v23
    v_mul_f32 v15, v15, v23
    v_add_f32 v20, v24, v25
    v_add_f32 v21, v26, v27
    v_cvt_pk_bf16_f32 v24, v24, v24
    v_cvt_pk_bf16_f32 v25, v25, v25
    v_cvt_pk_bf16_f32 v26, v26, v26
    v_cvt_pk_bf16_f32 v27, v27, v27
    v_add_f32 v20, v20, v21
    v_fma_f32 v11, v11, v23, v20
    v_and_b32 v28, v24, v6
    v_and_b32 v29, v24, v7
    v_and_b32 v30, v24, v8
    v_and_b32 v31, v24, v9
    v_and_b32 v32, v25, v6
    v_and_b32 v33, v25, v7
    v_and_b32 v34, v25, v8
    v_and_b32 v35, v25, v9
    v_and_b32 v36, v26, v6
    v_and_b32 v37, v26, v7
    v_and_b32 v38, v26, v8
    v_and_b32 v39, v26, v9
    v_and_b32 v40, v27, v6
    v_and_b32 v41, v27, v7
    v_and_b32 v42, v27, v8
    v_and_b32 v43, v27, v9
    s_waitcnt vmcnt(4)
    buffer_load_dwordx4 v[112:115], v3, s[12:15], s41 offen offset:0 nt
    buffer_load_dwordx4 v[116:119], v61, s[12:15], s41 offen offset:0 nt
    buffer_load_dwordx4 v[120:123], v62, s[12:15], s41 offen offset:0 nt
    buffer_load_dwordx4 v[124:127], v63, s[12:15], s41 offen offset:0 nt
    s_nop 1
    v_mfma_f32_16x16x32_bf16 v[12:15], v[28:31], v[176:179], v[12:15]
    v_mfma_f32_16x16x32_bf16 v[12:15], v[32:35], v[180:183], v[12:15]
    v_mfma_f32_16x16x32_bf16 v[12:15], v[36:39], v[184:187], v[12:15]
    v_mfma_f32_16x16x32_bf16 v[12:15], v[40:43], v[188:191], v[12:15]
    v_mfma_f32_16x16x32_bf16 v[16:19], v[192:195], v[44:47], 0
    v_mfma_f32_16x16x32_bf16 v[16:19], v[196:199], v[48:51], v[16:19]
    v_mfma_f32_16x16x32_bf16 v[16:19], v[200:203], v[52:55], v[16:19]
    v_mfma_f32_16x16x32_bf16 v[16:19], v[204:207], v[56:59], v[16:19]
    s_nop 7
    v_max3_f32 v20, v16, v17, v18
    v_max_f32 v20, v20, v19
    v_mov_b32 v21, v20
    s_nop 1
    v_permlane16_swap_b32 v20, v21
    v_max_f32 v20, v20, v21
    v_mov_b32 v21, v20
    s_nop 1
    v_permlane32_swap_b32 v20, v21
    v_max3_f32 v20, v20, v21, v10
    v_mul_f32 v22, s31, v20
    v_fma_f32 v23, v10, s30, v22
    v_fma_f32 v24, v16, s30, v22
    v_fma_f32 v25, v17, s30, v22
    v_fma_f32 v26, v18, s30, v22
    v_fma_f32 v27, v19, s30, v22
    v_exp_f32 v23, v23
    v_exp_f32 v24, v24
    v_exp_f32 v25, v25
    v_exp_f32 v26, v26
    v_exp_f32 v27, v27
    v_mov_b32 v10, v20
    v_mul_f32 v12, v12, v23
    v_mul_f32 v13, v13, v23
    v_mul_f32 v14, v14, v23
    v_mul_f32 v15, v15, v23
    v_add_f32 v20, v24, v25
    v_add_f32 v21, v26, v27
    v_cvt_pk_bf16_f32 v24, v24, v24
    v_cvt_pk_bf16_f32 v25, v25, v25
    v_cvt_pk_bf16_f32 v26, v26, v26
    v_cvt_pk_bf16_f32 v27, v27, v27
    v_add_f32 v20, v20, v21
    v_fma_f32 v11, v11, v23, v20
    v_and_b32 v28, v24, v6
    v_and_b32 v29, v24, v7
    v_and_b32 v30, v24, v8
    v_and_b32 v31, v24, v9
    v_and_b32 v32, v25, v6
    v_and_b32 v33, v25, v7
    v_and_b32 v34, v25, v8
    v_and_b32 v35, v25, v9
    v_and_b32 v36, v26, v6
    v_and_b32 v37, v26, v7
    v_and_b32 v38, v26, v8
    v_and_b32 v39, v26, v9
    v_and_b32 v40, v27, v6
    v_and_b32 v41, v27, v7
    v_and_b32 v42, v27, v8
    v_and_b32 v43, v27, v9
    s_waitcnt vmcnt(4)
    s_add_u32 s29, s27, 256
    s_bfe_u32 s38, s29, 0x10002
    s_lshl_b32 s38, s38, 11
    s_bfe_u32 s33, s29, 0x10003
    s_lshl_b32 s33, s33, 14
    s_add_u32 s38, s38, s33
    s_bfe_u32 s33, s29, 0x70004
    s_lshl_b32 s33, s33, 16
    s_add_u32 s38, s38, s33
    s_mov_b32 s29, s38
    s_lshr_b32 s33, s29, 7
    s_and_b32 s33, s33, 0x800
    s_xor_b32 s29, s29, s33
    s_lshr_b32 s33, s29, 5
    s_and_b32 s33, s33, 0x4000
    s_xor_b32 s29, s29, s33
    s_lshr_b32 s33, s29, 8
    s_and_b32 s33, s33, 0x3000
    s_xor_b32 s29, s29, s33
    s_xor_b32 s42, s29, s26
    buffer_load_dwordx4 v[128:131], v2, s[8:11], s42 offen offset:0 nt
    buffer_load_dwordx4 v[132:135], v2, s[8:11], s42 offen offset:64 nt
    buffer_load_dwordx4 v[136:139], v2, s[8:11], s42 offen offset:128 nt
    buffer_load_dwordx4 v[140:143], v2, s[8:11], s42 offen offset:192 nt
    s_nop 1
    v_mfma_f32_16x16x32_bf16 v[12:15], v[28:31], v[208:211], v[12:15]
    v_mfma_f32_16x16x32_bf16 v[12:15], v[32:35], v[212:215], v[12:15]
    v_mfma_f32_16x16x32_bf16 v[12:15], v[36:39], v[216:219], v[12:15]
    v_mfma_f32_16x16x32_bf16 v[12:15], v[40:43], v[220:223], v[12:15]
    v_mfma_f32_16x16x32_bf16 v[16:19], v[224:227], v[44:47], 0
    v_mfma_f32_16x16x32_bf16 v[16:19], v[228:231], v[48:51], v[16:19]
    v_mfma_f32_16x16x32_bf16 v[16:19], v[232:235], v[52:55], v[16:19]
    v_mfma_f32_16x16x32_bf16 v[16:19], v[236:239], v[56:59], v[16:19]
    s_nop 7
    v_max3_f32 v20, v16, v17, v18
    v_max_f32 v20, v20, v19
    v_mov_b32 v21, v20
    s_nop 1
    v_permlane16_swap_b32 v20, v21
    v_max_f32 v20, v20, v21
    v_mov_b32 v21, v20
    s_nop 1
    v_permlane32_swap_b32 v20, v21
    v_max3_f32 v20, v20, v21, v10
    v_mul_f32 v22, s31, v20
    v_fma_f32 v23, v10, s30, v22
    v_fma_f32 v24, v16, s30, v22
    v_fma_f32 v25, v17, s30, v22
    v_fma_f32 v26, v18, s30, v22
    v_fma_f32 v27, v19, s30, v22
    v_exp_f32 v23, v23
    v_exp_f32 v24, v24
    v_exp_f32 v25, v25
    v_exp_f32 v26, v26
    v_exp_f32 v27, v27
    v_mov_b32 v10, v20
    v_mul_f32 v12, v12, v23
    v_mul_f32 v13, v13, v23
    v_mul_f32 v14, v14, v23
    v_mul_f32 v15, v15, v23
    v_add_f32 v20, v24, v25
    v_add_f32 v21, v26, v27
    v_cvt_pk_bf16_f32 v24, v24, v24
    v_cvt_pk_bf16_f32 v25, v25, v25
    v_cvt_pk_bf16_f32 v26, v26, v26
    v_cvt_pk_bf16_f32 v27, v27, v27
    v_add_f32 v20, v20, v21
    v_fma_f32 v11, v11, v23, v20
    v_and_b32 v28, v24, v6
    v_and_b32 v29, v24, v7
    v_and_b32 v30, v24, v8
    v_and_b32 v31, v24, v9
    v_and_b32 v32, v25, v6
    v_and_b32 v33, v25, v7
    v_and_b32 v34, v25, v8
    v_and_b32 v35, v25, v9
    v_and_b32 v36, v26, v6
    v_and_b32 v37, v26, v7
    v_and_b32 v38, v26, v8
    v_and_b32 v39, v26, v9
    v_and_b32 v40, v27, v6
    v_and_b32 v41, v27, v7
    v_and_b32 v42, v27, v8
    v_and_b32 v43, v27, v9
    s_waitcnt vmcnt(4)
    buffer_load_dwordx4 v[144:147], v3, s[12:15], s42 offen offset:0 nt
    buffer_load_dwordx4 v[148:151], v61, s[12:15], s42 offen offset:0 nt
    buffer_load_dwordx4 v[152:155], v62, s[12:15], s42 offen offset:0 nt
    buffer_load_dwordx4 v[156:159], v63, s[12:15], s42 offen offset:0 nt
    s_nop 1
    v_mfma_f32_16x16x32_bf16 v[12:15], v[28:31], v[240:243], v[12:15]
    v_mfma_f32_16x16x32_bf16 v[12:15], v[32:35], v[244:247], v[12:15]
    v_mfma_f32_16x16x32_bf16 v[12:15], v[36:39], v[248:251], v[12:15]
    v_mfma_f32_16x16x32_bf16 v[12:15], v[40:43], v[252:255], v[12:15]
    v_mfma_f32_16x16x32_bf16 v[16:19], v[64:67], v[44:47], 0
    v_mfma_f32_16x16x32_bf16 v[16:19], v[68:71], v[48:51], v[16:19]
    v_mfma_f32_16x16x32_bf16 v[16:19], v[72:75], v[52:55], v[16:19]
    v_mfma_f32_16x16x32_bf16 v[16:19], v[76:79], v[56:59], v[16:19]
    s_nop 7
    v_max3_f32 v20, v16, v17, v18
    v_max_f32 v20, v20, v19
    v_mov_b32 v21, v20
    s_nop 1
    v_permlane16_swap_b32 v20, v21
    v_max_f32 v20, v20, v21
    v_mov_b32 v21, v20
    s_nop 1
    v_permlane32_swap_b32 v20, v21
    v_max3_f32 v20, v20, v21, v10
    v_mul_f32 v22, s31, v20
    v_fma_f32 v23, v10, s30, v22
    v_fma_f32 v24, v16, s30, v22
    v_fma_f32 v25, v17, s30, v22
    v_fma_f32 v26, v18, s30, v22
    v_fma_f32 v27, v19, s30, v22
    v_exp_f32 v23, v23
    v_exp_f32 v24, v24
    v_exp_f32 v25, v25
    v_exp_f32 v26, v26
    v_exp_f32 v27, v27
    v_mov_b32 v10, v20
    v_mul_f32 v12, v12, v23
    v_mul_f32 v13, v13, v23
    v_mul_f32 v14, v14, v23
    v_mul_f32 v15, v15, v23
    v_add_f32 v20, v24, v25
    v_add_f32 v21, v26, v27
    v_cvt_pk_bf16_f32 v24, v24, v24
    v_cvt_pk_bf16_f32 v25, v25, v25
    v_cvt_pk_bf16_f32 v26, v26, v26
    v_cvt_pk_bf16_f32 v27, v27, v27
    v_add_f32 v20, v20, v21
    v_fma_f32 v11, v11, v23, v20
    v_and_b32 v28, v24, v6
    v_and_b32 v29, v24, v7
    v_and_b32 v30, v24, v8
    v_and_b32 v31, v24, v9
    v_and_b32 v32, v25, v6
    v_and_b32 v33, v25, v7
    v_and_b32 v34, v25, v8
    v_and_b32 v35, v25, v9
    v_and_b32 v36, v26, v6
    v_and_b32 v37, v26, v7
    v_and_b32 v38, v26, v8
    v_and_b32 v39, v26, v9
    v_and_b32 v40, v27, v6
    v_and_b32 v41, v27, v7
    v_and_b32 v42, v27, v8
    v_and_b32 v43, v27, v9
    s_waitcnt vmcnt(4)
    s_add_u32 s29, s27, 288
    s_bfe_u32 s38, s29, 0x10002
    s_lshl_b32 s38, s38, 11
    s_bfe_u32 s33, s29, 0x10003
    s_lshl_b32 s33, s33, 14
    s_add_u32 s38, s38, s33
    s_bfe_u32 s33, s29, 0x70004
    s_lshl_b32 s33, s33, 16
    s_add_u32 s38, s38, s33
    s_mov_b32 s29, s38
    s_lshr_b32 s33, s29, 7
    s_and_b32 s33, s33, 0x800
    s_xor_b32 s29, s29, s33
    s_lshr_b32 s33, s29, 5
    s_and_b32 s33, s33, 0x4000
    s_xor_b32 s29, s29, s33
    s_lshr_b32 s33, s29, 8
    s_and_b32 s33, s33, 0x3000
    s_xor_b32 s29, s29, s33
    s_xor_b32 s43, s29, s26
    buffer_load_dwordx4 v[160:163], v2, s[8:11], s43 offen offset:0 nt
    buffer_load_dwordx4 v[164:167], v2, s[8:11], s43 offen offset:64 nt
    buffer_load_dwordx4 v[168:171], v2, s[8:11], s43 offen offset:128 nt
    buffer_load_dwordx4 v[172:175], v2, s[8:11], s43 offen offset:192 nt
    s_nop 1
    v_mfma_f32_16x16x32_bf16 v[12:15], v[28:31], v[80:83], v[12:15]
    v_mfma_f32_16x16x32_bf16 v[12:15], v[32:35], v[84:87], v[12:15]
    v_mfma_f32_16x16x32_bf16 v[12:15], v[36:39], v[88:91], v[12:15]
    v_mfma_f32_16x16x32_bf16 v[12:15], v[40:43], v[92:95], v[12:15]
    v_mfma_f32_16x16x32_bf16 v[16:19], v[96:99], v[44:47], 0
    v_mfma_f32_16x16x32_bf16 v[16:19], v[100:103], v[48:51], v[16:19]
    v_mfma_f32_16x16x32_bf16 v[16:19], v[104:107], v[52:55], v[16:19]
    v_mfma_f32_16x16x32_bf16 v[16:19], v[108:111], v[56:59], v[16:19]
    s_nop 7
    v_max3_f32 v20, v16, v17, v18
    v_max_f32 v20, v20, v19
    v_mov_b32 v21, v20
    s_nop 1
    v_permlane16_swap_b32 v20, v21
    v_max_f32 v20, v20, v21
    v_mov_b32 v21, v20
    s_nop 1
    v_permlane32_swap_b32 v20, v21
    v_max3_f32 v20, v20, v21, v10
    v_mul_f32 v22, s31, v20
    v_fma_f32 v23, v10, s30, v22
    v_fma_f32 v24, v16, s30, v22
    v_fma_f32 v25, v17, s30, v22
    v_fma_f32 v26, v18, s30, v22
    v_fma_f32 v27, v19, s30, v22
    v_exp_f32 v23, v23
    v_exp_f32 v24, v24
    v_exp_f32 v25, v25
    v_exp_f32 v26, v26
    v_exp_f32 v27, v27
    v_mov_b32 v10, v20
    v_mul_f32 v12, v12, v23
    v_mul_f32 v13, v13, v23
    v_mul_f32 v14, v14, v23
    v_mul_f32 v15, v15, v23
    v_add_f32 v20, v24, v25
    v_add_f32 v21, v26, v27
    v_cvt_pk_bf16_f32 v24, v24, v24
    v_cvt_pk_bf16_f32 v25, v25, v25
    v_cvt_pk_bf16_f32 v26, v26, v26
    v_cvt_pk_bf16_f32 v27, v27, v27
    v_add_f32 v20, v20, v21
    v_fma_f32 v11, v11, v23, v20
    v_and_b32 v28, v24, v6
    v_and_b32 v29, v24, v7
    v_and_b32 v30, v24, v8
    v_and_b32 v31, v24, v9
    v_and_b32 v32, v25, v6
    v_and_b32 v33, v25, v7
    v_and_b32 v34, v25, v8
    v_and_b32 v35, v25, v9
    v_and_b32 v36, v26, v6
    v_and_b32 v37, v26, v7
    v_and_b32 v38, v26, v8
    v_and_b32 v39, v26, v9
    v_and_b32 v40, v27, v6
    v_and_b32 v41, v27, v7
    v_and_b32 v42, v27, v8
    v_and_b32 v43, v27, v9
    s_waitcnt vmcnt(4)
    buffer_load_dwordx4 v[176:179], v3, s[12:15], s43 offen offset:0 nt
    buffer_load_dwordx4 v[180:183], v61, s[12:15], s43 offen offset:0 nt
    buffer_load_dwordx4 v[184:187], v62, s[12:15], s43 offen offset:0 nt
    buffer_load_dwordx4 v[188:191], v63, s[12:15], s43 offen offset:0 nt
    s_nop 1
    v_mfma_f32_16x16x32_bf16 v[12:15], v[28:31], v[112:115], v[12:15]
    v_mfma_f32_16x16x32_bf16 v[12:15], v[32:35], v[116:119], v[12:15]
    v_mfma_f32_16x16x32_bf16 v[12:15], v[36:39], v[120:123], v[12:15]
    v_mfma_f32_16x16x32_bf16 v[12:15], v[40:43], v[124:127], v[12:15]
    v_mfma_f32_16x16x32_bf16 v[16:19], v[128:131], v[44:47], 0
    v_mfma_f32_16x16x32_bf16 v[16:19], v[132:135], v[48:51], v[16:19]
    v_mfma_f32_16x16x32_bf16 v[16:19], v[136:139], v[52:55], v[16:19]
    v_mfma_f32_16x16x32_bf16 v[16:19], v[140:143], v[56:59], v[16:19]
    s_nop 7
    v_max3_f32 v20, v16, v17, v18
    v_max_f32 v20, v20, v19
    v_mov_b32 v21, v20
    s_nop 1
    v_permlane16_swap_b32 v20, v21
    v_max_f32 v20, v20, v21
    v_mov_b32 v21, v20
    s_nop 1
    v_permlane32_swap_b32 v20, v21
    v_max3_f32 v20, v20, v21, v10
    v_mul_f32 v22, s31, v20
    v_fma_f32 v23, v10, s30, v22
    v_fma_f32 v24, v16, s30, v22
    v_fma_f32 v25, v17, s30, v22
    v_fma_f32 v26, v18, s30, v22
    v_fma_f32 v27, v19, s30, v22
    v_exp_f32 v23, v23
    v_exp_f32 v24, v24
    v_exp_f32 v25, v25
    v_exp_f32 v26, v26
    v_exp_f32 v27, v27
    v_mov_b32 v10, v20
    v_mul_f32 v12, v12, v23
    v_mul_f32 v13, v13, v23
    v_mul_f32 v14, v14, v23
    v_mul_f32 v15, v15, v23
    v_add_f32 v20, v24, v25
    v_add_f32 v21, v26, v27
    v_cvt_pk_bf16_f32 v24, v24, v24
    v_cvt_pk_bf16_f32 v25, v25, v25
    v_cvt_pk_bf16_f32 v26, v26, v26
    v_cvt_pk_bf16_f32 v27, v27, v27
    v_add_f32 v20, v20, v21
    v_fma_f32 v11, v11, v23, v20
    v_and_b32 v28, v24, v6
    v_and_b32 v29, v24, v7
    v_and_b32 v30, v24, v8
    v_and_b32 v31, v24, v9
    v_and_b32 v32, v25, v6
    v_and_b32 v33, v25, v7
    v_and_b32 v34, v25, v8
    v_and_b32 v35, v25, v9
    v_and_b32 v36, v26, v6
    v_and_b32 v37, v26, v7
    v_and_b32 v38, v26, v8
    v_and_b32 v39, v26, v9
    v_and_b32 v40, v27, v6
    v_and_b32 v41, v27, v7
    v_and_b32 v42, v27, v8
    v_and_b32 v43, v27, v9
    s_waitcnt vmcnt(4)
    s_add_u32 s29, s27, 320
    s_bfe_u32 s38, s29, 0x10002
    s_lshl_b32 s38, s38, 11
    s_bfe_u32 s33, s29, 0x10003
    s_lshl_b32 s33, s33, 14
    s_add_u32 s38, s38, s33
    s_bfe_u32 s33, s29, 0x70004
    s_lshl_b32 s33, s33, 16
    s_add_u32 s38, s38, s33
    s_mov_b32 s29, s38
    s_lshr_b32 s33, s29, 7
    s_and_b32 s33, s33, 0x800
    s_xor_b32 s29, s29, s33
    s_lshr_b32 s33, s29, 5
    s_and_b32 s33, s33, 0x4000
    s_xor_b32 s29, s29, s33
    s_lshr_b32 s33, s29, 8
    s_and_b32 s33, s33, 0x3000
    s_xor_b32 s29, s29, s33
    s_xor_b32 s44, s29, s26
    buffer_load_dwordx4 v[192:195], v2, s[8:11], s44 offen offset:0 nt
    buffer_load_dwordx4 v[196:199], v2, s[8:11], s44 offen offset:64 nt
    buffer_load_dwordx4 v[200:203], v2, s[8:11], s44 offen offset:128 nt
    buffer_load_dwordx4 v[204:207], v2, s[8:11], s44 offen offset:192 nt
    s_nop 1
    v_mfma_f32_16x16x32_bf16 v[12:15], v[28:31], v[144:147], v[12:15]
    v_mfma_f32_16x16x32_bf16 v[12:15], v[32:35], v[148:151], v[12:15]
    v_mfma_f32_16x16x32_bf16 v[12:15], v[36:39], v[152:155], v[12:15]
    v_mfma_f32_16x16x32_bf16 v[12:15], v[40:43], v[156:159], v[12:15]
    v_mfma_f32_16x16x32_bf16 v[16:19], v[160:163], v[44:47], 0
    v_mfma_f32_16x16x32_bf16 v[16:19], v[164:167], v[48:51], v[16:19]
    v_mfma_f32_16x16x32_bf16 v[16:19], v[168:171], v[52:55], v[16:19]
    v_mfma_f32_16x16x32_bf16 v[16:19], v[172:175], v[56:59], v[16:19]
    s_nop 7
    v_max3_f32 v20, v16, v17, v18
    v_max_f32 v20, v20, v19
    v_mov_b32 v21, v20
    s_nop 1
    v_permlane16_swap_b32 v20, v21
    v_max_f32 v20, v20, v21
    v_mov_b32 v21, v20
    s_nop 1
    v_permlane32_swap_b32 v20, v21
    v_max3_f32 v20, v20, v21, v10
    v_mul_f32 v22, s31, v20
    v_fma_f32 v23, v10, s30, v22
    v_fma_f32 v24, v16, s30, v22
    v_fma_f32 v25, v17, s30, v22
    v_fma_f32 v26, v18, s30, v22
    v_fma_f32 v27, v19, s30, v22
    v_exp_f32 v23, v23
    v_exp_f32 v24, v24
    v_exp_f32 v25, v25
    v_exp_f32 v26, v26
    v_exp_f32 v27, v27
    v_mov_b32 v10, v20
    v_mul_f32 v12, v12, v23
    v_mul_f32 v13, v13, v23
    v_mul_f32 v14, v14, v23
    v_mul_f32 v15, v15, v23
    v_add_f32 v20, v24, v25
    v_add_f32 v21, v26, v27
    v_cvt_pk_bf16_f32 v24, v24, v24
    v_cvt_pk_bf16_f32 v25, v25, v25
    v_cvt_pk_bf16_f32 v26, v26, v26
    v_cvt_pk_bf16_f32 v27, v27, v27
    v_add_f32 v20, v20, v21
    v_fma_f32 v11, v11, v23, v20
    v_and_b32 v28, v24, v6
    v_and_b32 v29, v24, v7
    v_and_b32 v30, v24, v8
    v_and_b32 v31, v24, v9
    v_and_b32 v32, v25, v6
    v_and_b32 v33, v25, v7
    v_and_b32 v34, v25, v8
    v_and_b32 v35, v25, v9
    v_and_b32 v36, v26, v6
    v_and_b32 v37, v26, v7
    v_and_b32 v38, v26, v8
    v_and_b32 v39, v26, v9
    v_and_b32 v40, v27, v6
    v_and_b32 v41, v27, v7
    v_and_b32 v42, v27, v8
    v_and_b32 v43, v27, v9
    s_waitcnt vmcnt(4)
    buffer_load_dwordx4 v[208:211], v3, s[12:15], s44 offen offset:0 nt
    buffer_load_dwordx4 v[212:215], v61, s[12:15], s44 offen offset:0 nt
    buffer_load_dwordx4 v[216:219], v62, s[12:15], s44 offen offset:0 nt
    buffer_load_dwordx4 v[220:223], v63, s[12:15], s44 offen offset:0 nt
    s_nop 1
    v_mfma_f32_16x16x32_bf16 v[12:15], v[28:31], v[176:179], v[12:15]
    v_mfma_f32_16x16x32_bf16 v[12:15], v[32:35], v[180:183], v[12:15]
    v_mfma_f32_16x16x32_bf16 v[12:15], v[36:39], v[184:187], v[12:15]
    v_mfma_f32_16x16x32_bf16 v[12:15], v[40:43], v[188:191], v[12:15]
    s_add_u32 s27, s27, 352
    s_lshl_b32 s29, s23, 2
    s_add_u32 s29, s29, 5888
    v_mov_b32 v1, s29
    s_add_u32 s35, s23, 1888
    s_mov_b32 s28, 11
    v_mov_b32 v4, 4932
    v_mov_b32 v5, 11
L_loop:
    s_cmp_ge_u32 s44, 0x10000000
    s_cbranch_scc1 L_fin
    s_cmp_lt_u32 s28, 59
    s_cbranch_scc1 L_stat0
    s_waitcnt lgkmcnt(0)
    v_readfirstlane_b32 s29, v60
    s_cmp_eq_u32 s29, -1
    s_cbranch_scc1 L_spin0
L_back0:
    s_add_u32 s27, s29, s35
L_stat0:
    s_bfe_u32 s33, s27, 0x10002
    s_lshl_b32 s33, s33, 11
    s_bfe_u32 s37, s27, 0x10003
    s_lshl_b32 s37, s37, 14
    s_add_u32 s33, s33, s37
    s_bfe_u32 s37, s27, 0x70004
    s_lshl_b32 s37, s37, 16
    s_add_u32 s33, s33, s37
    s_lshr_b32 s37, s33, 7
    s_and_b32 s37, s37, 0x800
    s_xor_b32 s33, s33, s37
    s_lshr_b32 s37, s33, 5
    s_and_b32 s37, s37, 0x4000
    s_xor_b32 s33, s33, s37
    s_lshr_b32 s37, s33, 8
    s_and_b32 s37, s37, 0x3000
    s_xor_b32 s33, s33, s37
    s_xor_b32 s33, s33, s26
    s_cmp_lt_u32 s27, 2048
    s_cselect_b32 s45, s33, 0x10000000
    s_add_u32 s27, s27, 32
    s_add_u32 s28, s28, 1
    s_waitcnt vmcnt(4)
    buffer_load_dwordx4 v[224:227], v2, s[8:11], s45 offen offset:0 nt
    buffer_load_dwordx4 v[228:231], v2, s[8:11], s45 offen offset:64 nt
    buffer_load_dwordx4 v[232:235], v2, s[8:11], s45 offen offset:128 nt
    buffer_load_dwordx4 v[236:239], v2, s[8:11], s45 offen offset:192 nt
    ds_write_b32 v1, v5
    ds_read_b32 v60, v4
    v_mfma_f32_16x16x32_bf16 v[16:19], v[192:195], v[44:47], 0
    v_mfma_f32_16x16x32_bf16 v[16:19], v[196:199], v[48:51], v[16:19]
    v_mfma_f32_16x16x32_bf16 v[16:19], v[200:203], v[52:55], v[16:19]
    v_mfma_f32_16x16x32_bf16 v[16:19], v[204:207], v[56:59], v[16:19]
    v_add_u32 v5, 1, v5
    v_add_u32 v4, 4, v4
    s_nop 5
    v_max3_f32 v20, v16, v17, v18
    v_max_f32 v20, v20, v19
    v_mov_b32 v21, v20
    s_nop 1
    v_permlane16_swap_b32 v20, v21
    v_max_f32 v20, v20, v21
    v_mov_b32 v21, v20
    s_nop 1
    v_permlane32_swap_b32 v20, v21
    v_max3_f32 v20, v20, v21, v10
    v_mul_f32 v22, s31, v20
    v_fma_f32 v23, v10, s30, v22
    v_fma_f32 v24, v16, s30, v22
    v_fma_f32 v25, v17, s30, v22
    v_fma_f32 v26, v18, s30, v22
    v_fma_f32 v27, v19, s30, v22
    v_exp_f32 v23, v23
    v_exp_f32 v24, v24
    v_exp_f32 v25, v25
    v_exp_f32 v26, v26
    v_exp_f32 v27, v27
    v_mov_b32 v10, v20
    v_mul_f32 v12, v12, v23
    v_mul_f32 v13, v13, v23
    v_mul_f32 v14, v14, v23
    v_mul_f32 v15, v15, v23
    v_add_f32 v20, v24, v25
    v_add_f32 v21, v26, v27
    v_cvt_pk_bf16_f32 v24, v24, v24
    v_cvt_pk_bf16_f32 v25, v25, v25
    v_cvt_pk_bf16_f32 v26, v26, v26
    v_cvt_pk_bf16_f32 v27, v27, v27
    v_add_f32 v20, v20, v21
    v_fma_f32 v11, v11, v23, v20
    v_and_b32 v28, v24, v6
    v_and_b32 v29, v24, v7
    v_and_b32 v30, v24, v8
    v_and_b32 v31, v24, v9
    v_and_b32 v32, v25, v6
    v_and_b32 v33, v25, v7
    v_and_b32 v34, v25, v8
    v_and_b32 v35, v25, v9
    v_and_b32 v36, v26, v6
    v_and_b32 v37, v26, v7
    v_and_b32 v38, v26, v8
    v_and_b32 v39, v26, v9
    v_and_b32 v40, v27, v6
    v_and_b32 v41, v27, v7
    v_and_b32 v42, v27, v8
    v_and_b32 v43, v27, v9
    s_waitcnt vmcnt(4)
    buffer_load_dwordx4 v[240:243], v3, s[12:15], s45 offen offset:0 nt
    buffer_load_dwordx4 v[244:247], v61, s[12:15], s45 offen offset:0 nt
    buffer_load_dwordx4 v[248:251], v62, s[12:15], s45 offen offset:0 nt
    buffer_load_dwordx4 v[252:255], v63, s[12:15], s45 offen offset:0 nt
    v_mfma_f32_16x16x32_bf16 v[12:15], v[28:31], v[208:211], v[12:15]
    v_mfma_f32_16x16x32_bf16 v[12:15], v[32:35], v[212:215], v[12:15]
    v_mfma_f32_16x16x32_bf16 v[12:15], v[36:39], v[216:219], v[12:15]
    v_mfma_f32_16x16x32_bf16 v[12:15], v[40:43], v[220:223], v[12:15]
    s_cmp_ge_u32 s45, 0x10000000
    s_cbranch_scc1 L_fin
    s_cmp_lt_u32 s28, 59
    s_cbranch_scc1 L_stat1
    s_waitcnt lgkmcnt(0)
    v_readfirstlane_b32 s29, v60
    s_cmp_eq_u32 s29, -1
    s_cbranch_scc1 L_spin1
L_back1:
    s_add_u32 s27, s29, s35
L_stat1:
    s_bfe_u32 s33, s27, 0x10002
    s_lshl_b32 s33, s33, 11
    s_bfe_u32 s37, s27, 0x10003
    s_lshl_b32 s37, s37, 14
    s_add_u32 s33, s33, s37
    s_bfe_u32 s37, s27, 0x70004
    s_lshl_b32 s37, s37, 16
    s_add_u32 s33, s33, s37
    s_lshr_b32 s37, s33, 7
    s_and_b32 s37, s37, 0x800
    s_xor_b32 s33, s33, s37
    s_lshr_b32 s37, s33, 5
    s_and_b32 s37, s37, 0x4000
    s_xor_b32 s33, s33, s37
    s_lshr_b32 s37, s33, 8
    s_and_b32 s37, s37, 0x3000
    s_xor_b32 s33, s33, s37
    s_xor_b32 s33, s33, s26
    s_cmp_lt_u32 s27, 2048
    s_cselect_b32 s40, s33, 0x10000000
    s_add_u32 s27, s27, 32
    s_add_u32 s28, s28, 1
    s_waitcnt vmcnt(4)
    buffer_load_dwordx4 v[64:67], v2, s[8:11], s40 offen offset:0 nt
    buffer_load_dwordx4 v[68:71], v2, s[8:11], s40 offen offset:64 nt
    buffer_load_dwordx4 v[72:75], v2, s[8:11], s40 offen offset:128 nt
    buffer_load_dwordx4 v[76:79], v2, s[8:11], s40 offen offset:192 nt
    ds_write_b32 v1, v5
    ds_read_b32 v60, v4
    v_mfma_f32_16x16x32_bf16 v[16:19], v[224:227], v[44:47], 0
    v_mfma_f32_16x16x32_bf16 v[16:19], v[228:231], v[48:51], v[16:19]
    v_mfma_f32_16x16x32_bf16 v[16:19], v[232:235], v[52:55], v[16:19]
    v_mfma_f32_16x16x32_bf16 v[16:19], v[236:239], v[56:59], v[16:19]
    v_add_u32 v5, 1, v5
    v_add_u32 v4, 4, v4
    s_nop 5
    v_max3_f32 v20, v16, v17, v18
    v_max_f32 v20, v20, v19
    v_mov_b32 v21, v20
    s_nop 1
    v_permlane16_swap_b32 v20, v21
    v_max_f32 v20, v20, v21
    v_mov_b32 v21, v20
    s_nop 1
    v_permlane32_swap_b32 v20, v21
    v_max3_f32 v20, v20, v21, v10
    v_mul_f32 v22, s31, v20
    v_fma_f32 v23, v10, s30, v22
    v_fma_f32 v24, v16, s30, v22
    v_fma_f32 v25, v17, s30, v22
    v_fma_f32 v26, v18, s30, v22
    v_fma_f32 v27, v19, s30, v22
    v_exp_f32 v23, v23
    v_exp_f32 v24, v24
    v_exp_f32 v25, v25
    v_exp_f32 v26, v26
    v_exp_f32 v27, v27
    v_mov_b32 v10, v20
    v_mul_f32 v12, v12, v23
    v_mul_f32 v13, v13, v23
    v_mul_f32 v14, v14, v23
    v_mul_f32 v15, v15, v23
    v_add_f32 v20, v24, v25
    v_add_f32 v21, v26, v27
    v_cvt_pk_bf16_f32 v24, v24, v24
    v_cvt_pk_bf16_f32 v25, v25, v25
    v_cvt_pk_bf16_f32 v26, v26, v26
    v_cvt_pk_bf16_f32 v27, v27, v27
    v_add_f32 v20, v20, v21
    v_fma_f32 v11, v11, v23, v20
    v_and_b32 v28, v24, v6
    v_and_b32 v29, v24, v7
    v_and_b32 v30, v24, v8
    v_and_b32 v31, v24, v9
    v_and_b32 v32, v25, v6
    v_and_b32 v33, v25, v7
    v_and_b32 v34, v25, v8
    v_and_b32 v35, v25, v9
    v_and_b32 v36, v26, v6
    v_and_b32 v37, v26, v7
    v_and_b32 v38, v26, v8
    v_and_b32 v39, v26, v9
    v_and_b32 v40, v27, v6
    v_and_b32 v41, v27, v7
    v_and_b32 v42, v27, v8
    v_and_b32 v43, v27, v9
    s_waitcnt vmcnt(4)
    buffer_load_dwordx4 v[80:83], v3, s[12:15], s40 offen offset:0 nt
    buffer_load_dwordx4 v[84:87], v61, s[12:15], s40 offen offset:0 nt
    buffer_load_dwordx4 v[88:91], v62, s[12:15], s40 offen offset:0 nt
    buffer_load_dwordx4 v[92:95], v63, s[12:15], s40 offen offset:0 nt
    v_mfma_f32_16x16x32_bf16 v[12:15], v[28:31], v[240:243], v[12:15]
    v_mfma_f32_16x16x32_bf16 v[12:15], v[32:35], v[244:247], v[12:15]
    v_mfma_f32_16x16x32_bf16 v[12:15], v[36:39], v[248:251], v[12:15]
    v_mfma_f32_16x16x32_bf16 v[12:15], v[40:43], v[252:255], v[12:15]
    s_cmp_ge_u32 s40, 0x10000000
    s_cbranch_scc1 L_fin
    s_cmp_lt_u32 s28, 59
    s_cbranch_scc1 L_stat2
    s_waitcnt lgkmcnt(0)
    v_readfirstlane_b32 s29, v60
    s_cmp_eq_u32 s29, -1
    s_cbranch_scc1 L_spin2
L_back2:
    s_add_u32 s27, s29, s35
L_stat2:
    s_bfe_u32 s33, s27, 0x10002
    s_lshl_b32 s33, s33, 11
    s_bfe_u32 s37, s27, 0x10003
    s_lshl_b32 s37, s37, 14
    s_add_u32 s33, s33, s37
    s_bfe_u32 s37, s27, 0x70004
    s_lshl_b32 s37, s37, 16
    s_add_u32 s33, s33, s37
    s_lshr_b32 s37, s33, 7
    s_and_b32 s37, s37, 0x800
    s_xor_b32 s33, s33, s37
    s_lshr_b32 s37, s33, 5
    s_and_b32 s37, s37, 0x4000
    s_xor_b32 s33, s33, s37
    s_lshr_b32 s37, s33, 8
    s_and_b32 s37, s37, 0x3000
    s_xor_b32 s33, s33, s37
    s_xor_b32 s33, s33, s26
    s_cmp_lt_u32 s27, 2048
    s_cselect_b32 s41, s33, 0x10000000
    s_add_u32 s27, s27, 32
    s_add_u32 s28, s28, 1
    s_waitcnt vmcnt(4)
    buffer_load_dwordx4 v[96:99], v2, s[8:11], s41 offen offset:0 nt
    buffer_load_dwordx4 v[100:103], v2, s[8:11], s41 offen offset:64 nt
    buffer_load_dwordx4 v[104:107], v2, s[8:11], s41 offen offset:128 nt
    buffer_load_dwordx4 v[108:111], v2, s[8:11], s41 offen offset:192 nt
    ds_write_b32 v1, v5
    ds_read_b32 v60, v4
    v_mfma_f32_16x16x32_bf16 v[16:19], v[64:67], v[44:47], 0
    v_mfma_f32_16x16x32_bf16 v[16:19], v[68:71], v[48:51], v[16:19]
    v_mfma_f32_16x16x32_bf16 v[16:19], v[72:75], v[52:55], v[16:19]
    v_mfma_f32_16x16x32_bf16 v[16:19], v[76:79], v[56:59], v[16:19]
    v_add_u32 v5, 1, v5
    v_add_u32 v4, 4, v4
    s_nop 5
    v_max3_f32 v20, v16, v17, v18
    v_max_f32 v20, v20, v19
    v_mov_b32 v21, v20
    s_nop 1
    v_permlane16_swap_b32 v20, v21
    v_max_f32 v20, v20, v21
    v_mov_b32 v21, v20
    s_nop 1
    v_permlane32_swap_b32 v20, v21
    v_max3_f32 v20, v20, v21, v10
    v_mul_f32 v22, s31, v20
    v_fma_f32 v23, v10, s30, v22
    v_fma_f32 v24, v16, s30, v22
    v_fma_f32 v25, v17, s30, v22
    v_fma_f32 v26, v18, s30, v22
    v_fma_f32 v27, v19, s30, v22
    v_exp_f32 v23, v23
    v_exp_f32 v24, v24
    v_exp_f32 v25, v25
    v_exp_f32 v26, v26
    v_exp_f32 v27, v27
    v_mov_b32 v10, v20
    v_mul_f32 v12, v12, v23
    v_mul_f32 v13, v13, v23
    v_mul_f32 v14, v14, v23
    v_mul_f32 v15, v15, v23
    v_add_f32 v20, v24, v25
    v_add_f32 v21, v26, v27
    v_cvt_pk_bf16_f32 v24, v24, v24
    v_cvt_pk_bf16_f32 v25, v25, v25
    v_cvt_pk_bf16_f32 v26, v26, v26
    v_cvt_pk_bf16_f32 v27, v27, v27
    v_add_f32 v20, v20, v21
    v_fma_f32 v11, v11, v23, v20
    v_and_b32 v28, v24, v6
    v_and_b32 v29, v24, v7
    v_and_b32 v30, v24, v8
    v_and_b32 v31, v24, v9
    v_and_b32 v32, v25, v6
    v_and_b32 v33, v25, v7
    v_and_b32 v34, v25, v8
    v_and_b32 v35, v25, v9
    v_and_b32 v36, v26, v6
    v_and_b32 v37, v26, v7
    v_and_b32 v38, v26, v8
    v_and_b32 v39, v26, v9
    v_and_b32 v40, v27, v6
    v_and_b32 v41, v27, v7
    v_and_b32 v42, v27, v8
    v_and_b32 v43, v27, v9
    s_waitcnt vmcnt(4)
    buffer_load_dwordx4 v[112:115], v3, s[12:15], s41 offen offset:0 nt
    buffer_load_dwordx4 v[116:119], v61, s[12:15], s41 offen offset:0 nt
    buffer_load_dwordx4 v[120:123], v62, s[12:15], s41 offen offset:0 nt
    buffer_load_dwordx4 v[124:127], v63, s[12:15], s41 offen offset:0 nt
    v_mfma_f32_16x16x32_bf16 v[12:15], v[28:31], v[80:83], v[12:15]
    v_mfma_f32_16x16x32_bf16 v[12:15], v[32:35], v[84:87], v[12:15]
    v_mfma_f32_16x16x32_bf16 v[12:15], v[36:39], v[88:91], v[12:15]
    v_mfma_f32_16x16x32_bf16 v[12:15], v[40:43], v[92:95], v[12:15]
    s_cmp_ge_u32 s41, 0x10000000
    s_cbranch_scc1 L_fin
    s_cmp_lt_u32 s28, 59
    s_cbranch_scc1 L_stat3
    s_waitcnt lgkmcnt(0)
    v_readfirstlane_b32 s29, v60
    s_cmp_eq_u32 s29, -1
    s_cbranch_scc1 L_spin3
L_back3:
    s_add_u32 s27, s29, s35
L_stat3:
    s_bfe_u32 s33, s27, 0x10002
    s_lshl_b32 s33, s33, 11
    s_bfe_u32 s37, s27, 0x10003
    s_lshl_b32 s37, s37, 14
    s_add_u32 s33, s33, s37
    s_bfe_u32 s37, s27, 0x70004
    s_lshl_b32 s37, s37, 16
    s_add_u32 s33, s33, s37
    s_lshr_b32 s37, s33, 7
    s_and_b32 s37, s37, 0x800
    s_xor_b32 s33, s33, s37
    s_lshr_b32 s37, s33, 5
    s_and_b32 s37, s37, 0x4000
    s_xor_b32 s33, s33, s37
    s_lshr_b32 s37, s33, 8
    s_and_b32 s37, s37, 0x3000
    s_xor_b32 s33, s33, s37
    s_xor_b32 s33, s33, s26
    s_cmp_lt_u32 s27, 2048
    s_cselect_b32 s42, s33, 0x10000000
    s_add_u32 s27, s27, 32
    s_add_u32 s28, s28, 1
    s_waitcnt vmcnt(4)
    buffer_load_dwordx4 v[128:131], v2, s[8:11], s42 offen offset:0 nt
    buffer_load_dwordx4 v[132:135], v2, s[8:11], s42 offen offset:64 nt
    buffer_load_dwordx4 v[136:139], v2, s[8:11], s42 offen offset:128 nt
    buffer_load_dwordx4 v[140:143], v2, s[8:11], s42 offen offset:192 nt
    ds_write_b32 v1, v5
    ds_read_b32 v60, v4
    v_mfma_f32_16x16x32_bf16 v[16:19], v[96:99], v[44:47], 0
    v_mfma_f32_16x16x32_bf16 v[16:19], v[100:103], v[48:51], v[16:19]
    v_mfma_f32_16x16x32_bf16 v[16:19], v[104:107], v[52:55], v[16:19]
    v_mfma_f32_16x16x32_bf16 v[16:19], v[108:111], v[56:59], v[16:19]
    v_add_u32 v5, 1, v5
    v_add_u32 v4, 4, v4
    s_nop 5
    v_max3_f32 v20, v16, v17, v18
    v_max_f32 v20, v20, v19
    v_mov_b32 v21, v20
    s_nop 1
    v_permlane16_swap_b32 v20, v21
    v_max_f32 v20, v20, v21
    v_mov_b32 v21, v20
    s_nop 1
    v_permlane32_swap_b32 v20, v21
    v_max3_f32 v20, v20, v21, v10
    v_mul_f32 v22, s31, v20
    v_fma_f32 v23, v10, s30, v22
    v_fma_f32 v24, v16, s30, v22
    v_fma_f32 v25, v17, s30, v22
    v_fma_f32 v26, v18, s30, v22
    v_fma_f32 v27, v19, s30, v22
    v_exp_f32 v23, v23
    v_exp_f32 v24, v24
    v_exp_f32 v25, v25
    v_exp_f32 v26, v26
    v_exp_f32 v27, v27
    v_mov_b32 v10, v20
    v_mul_f32 v12, v12, v23
    v_mul_f32 v13, v13, v23
    v_mul_f32 v14, v14, v23
    v_mul_f32 v15, v15, v23
    v_add_f32 v20, v24, v25
    v_add_f32 v21, v26, v27
    v_cvt_pk_bf16_f32 v24, v24, v24
    v_cvt_pk_bf16_f32 v25, v25, v25
    v_cvt_pk_bf16_f32 v26, v26, v26
    v_cvt_pk_bf16_f32 v27, v27, v27
    v_add_f32 v20, v20, v21
    v_fma_f32 v11, v11, v23, v20
    v_and_b32 v28, v24, v6
    v_and_b32 v29, v24, v7
    v_and_b32 v30, v24, v8
    v_and_b32 v31, v24, v9
    v_and_b32 v32, v25, v6
    v_and_b32 v33, v25, v7
    v_and_b32 v34, v25, v8
    v_and_b32 v35, v25, v9
    v_and_b32 v36, v26, v6
    v_and_b32 v37, v26, v7
    v_and_b32 v38, v26, v8
    v_and_b32 v39, v26, v9
    v_and_b32 v40, v27, v6
    v_and_b32 v41, v27, v7
    v_and_b32 v42, v27, v8
    v_and_b32 v43, v27, v9
    s_waitcnt vmcnt(4)
    buffer_load_dwordx4 v[144:147], v3, s[12:15], s42 offen offset:0 nt
    buffer_load_dwordx4 v[148:151], v61, s[12:15], s42 offen offset:0 nt
    buffer_load_dwordx4 v[152:155], v62, s[12:15], s42 offen offset:0 nt
    buffer_load_dwordx4 v[156:159], v63, s[12:15], s42 offen offset:0 nt
    v_mfma_f32_16x16x32_bf16 v[12:15], v[28:31], v[112:115], v[12:15]
    v_mfma_f32_16x16x32_bf16 v[12:15], v[32:35], v[116:119], v[12:15]
    v_mfma_f32_16x16x32_bf16 v[12:15], v[36:39], v[120:123], v[12:15]
    v_mfma_f32_16x16x32_bf16 v[12:15], v[40:43], v[124:127], v[12:15]
    s_cmp_ge_u32 s42, 0x10000000
    s_cbranch_scc1 L_fin
    s_cmp_lt_u32 s28, 59
    s_cbranch_scc1 L_stat4
    s_waitcnt lgkmcnt(0)
    v_readfirstlane_b32 s29, v60
    s_cmp_eq_u32 s29, -1
    s_cbranch_scc1 L_spin4
L_back4:
    s_add_u32 s27, s29, s35
L_stat4:
    s_bfe_u32 s33, s27, 0x10002
    s_lshl_b32 s33, s33, 11
    s_bfe_u32 s37, s27, 0x10003
    s_lshl_b32 s37, s37, 14
    s_add_u32 s33, s33, s37
    s_bfe_u32 s37, s27, 0x70004
    s_lshl_b32 s37, s37, 16
    s_add_u32 s33, s33, s37
    s_lshr_b32 s37, s33, 7
    s_and_b32 s37, s37, 0x800
    s_xor_b32 s33, s33, s37
    s_lshr_b32 s37, s33, 5
    s_and_b32 s37, s37, 0x4000
    s_xor_b32 s33, s33, s37
    s_lshr_b32 s37, s33, 8
    s_and_b32 s37, s37, 0x3000
    s_xor_b32 s33, s33, s37
    s_xor_b32 s33, s33, s26
    s_cmp_lt_u32 s27, 2048
    s_cselect_b32 s43, s33, 0x10000000
    s_add_u32 s27, s27, 32
    s_add_u32 s28, s28, 1
    s_waitcnt vmcnt(4)
    buffer_load_dwordx4 v[160:163], v2, s[8:11], s43 offen offset:0 nt
    buffer_load_dwordx4 v[164:167], v2, s[8:11], s43 offen offset:64 nt
    buffer_load_dwordx4 v[168:171], v2, s[8:11], s43 offen offset:128 nt
    buffer_load_dwordx4 v[172:175], v2, s[8:11], s43 offen offset:192 nt
    ds_write_b32 v1, v5
    ds_read_b32 v60, v4
    v_mfma_f32_16x16x32_bf16 v[16:19], v[128:131], v[44:47], 0
    v_mfma_f32_16x16x32_bf16 v[16:19], v[132:135], v[48:51], v[16:19]
    v_mfma_f32_16x16x32_bf16 v[16:19], v[136:139], v[52:55], v[16:19]
    v_mfma_f32_16x16x32_bf16 v[16:19], v[140:143], v[56:59], v[16:19]
    v_add_u32 v5, 1, v5
    v_add_u32 v4, 4, v4
    s_nop 5
    v_max3_f32 v20, v16, v17, v18
    v_max_f32 v20, v20, v19
    v_mov_b32 v21, v20
    s_nop 1
    v_permlane16_swap_b32 v20, v21
    v_max_f32 v20, v20, v21
    v_mov_b32 v21, v20
    s_nop 1
    v_permlane32_swap_b32 v20, v21
    v_max3_f32 v20, v20, v21, v10
    v_mul_f32 v22, s31, v20
    v_fma_f32 v23, v10, s30, v22
    v_fma_f32 v24, v16, s30, v22
    v_fma_f32 v25, v17, s30, v22
    v_fma_f32 v26, v18, s30, v22
    v_fma_f32 v27, v19, s30, v22
    v_exp_f32 v23, v23
    v_exp_f32 v24, v24
    v_exp_f32 v25, v25
    v_exp_f32 v26, v26
    v_exp_f32 v27, v27
    v_mov_b32 v10, v20
    v_mul_f32 v12, v12, v23
    v_mul_f32 v13, v13, v23
    v_mul_f32 v14, v14, v23
    v_mul_f32 v15, v15, v23
    v_add_f32 v20, v24, v25
    v_add_f32 v21, v26, v27
    v_cvt_pk_bf16_f32 v24, v24, v24
    v_cvt_pk_bf16_f32 v25, v25, v25
    v_cvt_pk_bf16_f32 v26, v26, v26
    v_cvt_pk_bf16_f32 v27, v27, v27
    v_add_f32 v20, v20, v21
    v_fma_f32 v11, v11, v23, v20
    v_and_b32 v28, v24, v6
    v_and_b32 v29, v24, v7
    v_and_b32 v30, v24, v8
    v_and_b32 v31, v24, v9
    v_and_b32 v32, v25, v6
    v_and_b32 v33, v25, v7
    v_and_b32 v34, v25, v8
    v_and_b32 v35, v25, v9
    v_and_b32 v36, v26, v6
    v_and_b32 v37, v26, v7
    v_and_b32 v38, v26, v8
    v_and_b32 v39, v26, v9
    v_and_b32 v40, v27, v6
    v_and_b32 v41, v27, v7
    v_and_b32 v42, v27, v8
    v_and_b32 v43, v27, v9
    s_waitcnt vmcnt(4)
    buffer_load_dwordx4 v[176:179], v3, s[12:15], s43 offen offset:0 nt
    buffer_load_dwordx4 v[180:183], v61, s[12:15], s43 offen offset:0 nt
    buffer_load_dwordx4 v[184:187], v62, s[12:15], s43 offen offset:0 nt
    buffer_load_dwordx4 v[188:191], v63, s[12:15], s43 offen offset:0 nt
    v_mfma_f32_16x16x32_bf16 v[12:15], v[28:31], v[144:147], v[12:15]
    v_mfma_f32_16x16x32_bf16 v[12:15], v[32:35], v[148:151], v[12:15]
    v_mfma_f32_16x16x32_bf16 v[12:15], v[36:39], v[152:155], v[12:15]
    v_mfma_f32_16x16x32_bf16 v[12:15], v[40:43], v[156:159], v[12:15]
    s_cmp_ge_u32 s43, 0x10000000
    s_cbranch_scc1 L_fin
    s_cmp_lt_u32 s28, 59
    s_cbranch_scc1 L_stat5
    s_waitcnt lgkmcnt(0)
    v_readfirstlane_b32 s29, v60
    s_cmp_eq_u32 s29, -1
    s_cbranch_scc1 L_spin5
L_back5:
    s_add_u32 s27, s29, s35
L_stat5:
    s_bfe_u32 s33, s27, 0x10002
    s_lshl_b32 s33, s33, 11
    s_bfe_u32 s37, s27, 0x10003
    s_lshl_b32 s37, s37, 14
    s_add_u32 s33, s33, s37
    s_bfe_u32 s37, s27, 0x70004
    s_lshl_b32 s37, s37, 16
    s_add_u32 s33, s33, s37
    s_lshr_b32 s37, s33, 7
    s_and_b32 s37, s37, 0x800
    s_xor_b32 s33, s33, s37
    s_lshr_b32 s37, s33, 5
    s_and_b32 s37, s37, 0x4000
    s_xor_b32 s33, s33, s37
    s_lshr_b32 s37, s33, 8
    s_and_b32 s37, s37, 0x3000
    s_xor_b32 s33, s33, s37
    s_xor_b32 s33, s33, s26
    s_cmp_lt_u32 s27, 2048
    s_cselect_b32 s44, s33, 0x10000000
    s_add_u32 s27, s27, 32
    s_add_u32 s28, s28, 1
    s_waitcnt vmcnt(4)
    buffer_load_dwordx4 v[192:195], v2, s[8:11], s44 offen offset:0 nt
    buffer_load_dwordx4 v[196:199], v2, s[8:11], s44 offen offset:64 nt
    buffer_load_dwordx4 v[200:203], v2, s[8:11], s44 offen offset:128 nt
    buffer_load_dwordx4 v[204:207], v2, s[8:11], s44 offen offset:192 nt
    ds_write_b32 v1, v5
    ds_read_b32 v60, v4
    v_mfma_f32_16x16x32_bf16 v[16:19], v[160:163], v[44:47], 0
    v_mfma_f32_16x16x32_bf16 v[16:19], v[164:167], v[48:51], v[16:19]
    v_mfma_f32_16x16x32_bf16 v[16:19], v[168:171], v[52:55], v[16:19]
    v_mfma_f32_16x16x32_bf16 v[16:19], v[172:175], v[56:59], v[16:19]
    v_add_u32 v5, 1, v5
    v_add_u32 v4, 4, v4
    s_nop 5
    v_max3_f32 v20, v16, v17, v18
    v_max_f32 v20, v20, v19
    v_mov_b32 v21, v20
    s_nop 1
    v_permlane16_swap_b32 v20, v21
    v_max_f32 v20, v20, v21
    v_mov_b32 v21, v20
    s_nop 1
    v_permlane32_swap_b32 v20, v21
    v_max3_f32 v20, v20, v21, v10
    v_mul_f32 v22, s31, v20
    v_fma_f32 v23, v10, s30, v22
    v_fma_f32 v24, v16, s30, v22
    v_fma_f32 v25, v17, s30, v22
    v_fma_f32 v26, v18, s30, v22
    v_fma_f32 v27, v19, s30, v22
    v_exp_f32 v23, v23
    v_exp_f32 v24, v24
    v_exp_f32 v25, v25
    v_exp_f32 v26, v26
    v_exp_f32 v27, v27
    v_mov_b32 v10, v20
    v_mul_f32 v12, v12, v23
    v_mul_f32 v13, v13, v23
    v_mul_f32 v14, v14, v23
    v_mul_f32 v15, v15, v23
    v_add_f32 v20, v24, v25
    v_add_f32 v21, v26, v27
    v_cvt_pk_bf16_f32 v24, v24, v24
    v_cvt_pk_bf16_f32 v25, v25, v25
    v_cvt_pk_bf16_f32 v26, v26, v26
    v_cvt_pk_bf16_f32 v27, v27, v27
    v_add_f32 v20, v20, v21
    v_fma_f32 v11, v11, v23, v20
    v_and_b32 v28, v24, v6
    v_and_b32 v29, v24, v7
    v_and_b32 v30, v24, v8
    v_and_b32 v31, v24, v9
    v_and_b32 v32, v25, v6
    v_and_b32 v33, v25, v7
    v_and_b32 v34, v25, v8
    v_and_b32 v35, v25, v9
    v_and_b32 v36, v26, v6
    v_and_b32 v37, v26, v7
    v_and_b32 v38, v26, v8
    v_and_b32 v39, v26, v9
    v_and_b32 v40, v27, v6
    v_and_b32 v41, v27, v7
    v_and_b32 v42, v27, v8
    v_and_b32 v43, v27, v9
    s_waitcnt vmcnt(4)
    buffer_load_dwordx4 v[208:211], v3, s[12:15], s44 offen offset:0 nt
    buffer_load_dwordx4 v[212:215], v61, s[12:15], s44 offen offset:0 nt
    buffer_load_dwordx4 v[216:219], v62, s[12:15], s44 offen offset:0 nt
    buffer_load_dwordx4 v[220:223], v63, s[12:15], s44 offen offset:0 nt
    v_mfma_f32_16x16x32_bf16 v[12:15], v[28:31], v[176:179], v[12:15]
    v_mfma_f32_16x16x32_bf16 v[12:15], v[32:35], v[180:183], v[12:15]
    v_mfma_f32_16x16x32_bf16 v[12:15], v[36:39], v[184:187], v[12:15]
    v_mfma_f32_16x16x32_bf16 v[12:15], v[40:43], v[188:191], v[12:15]
    s_branch L_loop
L_spin0:
    s_mov_b32 s34, 400000
    v_add_u32 v20, -4, v4
L_spin0_l:
    ds_read_b32 v60, v20
    s_waitcnt lgkmcnt(0)
    v_readfirstlane_b32 s29, v60
    s_cmp_lg_u32 s29, -1
    s_cbranch_scc1 L_back0
    s_sleep 1
    s_sub_u32 s34, s34, 1
    s_cmp_lg_u32 s34, 0
    s_cbranch_scc1 L_spin0_l
    s_mov_b32 s29, 160
    s_branch L_back0
L_spin1:
    s_mov_b32 s34, 400000
    v_add_u32 v20, -4, v4
L_spin1_l:
    ds_read_b32 v60, v20
    s_waitcnt lgkmcnt(0)
    v_readfirstlane_b32 s29, v60
    s_cmp_lg_u32 s29, -1
    s_cbranch_scc1 L_back1
    s_sleep 1
    s_sub_u32 s34, s34, 1
    s_cmp_lg_u32 s34, 0
    s_cbranch_scc1 L_spin1_l
    s_mov_b32 s29, 160
    s_branch L_back1
L_spin2:
    s_mov_b32 s34, 400000
    v_add_u32 v20, -4, v4
L_spin2_l:
    ds_read_b32 v60, v20
    s_waitcnt lgkmcnt(0)
    v_readfirstlane_b32 s29, v60
    s_cmp_lg_u32 s29, -1
    s_cbranch_scc1 L_back2
    s_sleep 1
    s_sub_u32 s34, s34, 1
    s_cmp_lg_u32 s34, 0
    s_cbranch_scc1 L_spin2_l
    s_mov_b32 s29, 160
    s_branch L_back2
L_spin3:
    s_mov_b32 s34, 400000
    v_add_u32 v20, -4, v4
L_spin3_l:
    ds_read_b32 v60, v20
    s_waitcnt lgkmcnt(0)
    v_readfirstlane_b32 s29, v60
    s_cmp_lg_u32 s29, -1
    s_cbranch_scc1 L_back3
    s_sleep 1
    s_sub_u32 s34, s34, 1
    s_cmp_lg_u32 s34, 0
    s_cbranch_scc1 L_spin3_l
    s_mov_b32 s29, 160
    s_branch L_back3
L_spin4:
    s_mov_b32 s34, 400000
    v_add_u32 v20, -4, v4
L_spin4_l:
    ds_read_b32 v60, v20
    s_waitcnt lgkmcnt(0)
    v_readfirstlane_b32 s29, v60
    s_cmp_lg_u32 s29, -1
    s_cbranch_scc1 L_back4
    s_sleep 1
    s_sub_u32 s34, s34, 1
    s_cmp_lg_u32 s34, 0
    s_cbranch_scc1 L_spin4_l
    s_mov_b32 s29, 160
    s_branch L_back4
L_spin5:
    s_mov_b32 s34, 400000
    v_add_u32 v20, -4, v4
L_spin5_l:
    ds_read_b32 v60, v20
    s_waitcnt lgkmcnt(0)
    v_readfirstlane_b32 s29, v60
    s_cmp_lg_u32 s29, -1
    s_cbranch_scc1 L_back5
    s_sleep 1
    s_sub_u32 s34, s34, 1
    s_cmp_lg_u32 s34, 0
    s_cbranch_scc1 L_spin5_l
    s_mov_b32 s29, 160
    s_branch L_back5
L_fin:
    s_nop 7
    v_lshrrev_b32 v20, 4, v0
    v_and_b32 v21, 15, v0
    s_lshl_b32 s29, s23, 5
    s_add_u32 s29, s29, 4352
    v_lshlrev_b32 v22, 2, v20
    v_add_u32 v22, s29, v22
    ds_write_b32 v22, v11
    v_mov_b32 v22, s29
    ds_write_b32 v22, v10 offset:16
    s_lshl_b32 s29, s23, 9
    s_add_u32 s29, s29, 2304
    v_lshlrev_b32 v22, 5, v21
    v_lshl_add_u32 v22, v20, 4, v22
    v_add_u32 v22, s29, v22
    s_mov_b32 exec_hi, 0
    ds_write_b128 v22, v[12:15]
    s_mov_b32 exec_hi, -1
    s_waitcnt lgkmcnt(0)
    s_barrier
    s_waitcnt vmcnt(0)
    s_cmp_lg_u32 s23, 1
    s_cbranch_scc1 L_sback
    s_cmp_lt_u32 s21, 4
    s_cbranch_scc1 L_scons
L_sback:
    s_endpgm
L_helper:
    s_load_dwordx2 s[4:5], s[0:1], 0
    s_load_dwordx4 s[36:39], s[0:1], 24
    s_load_dwordx4 s[44:47], s[0:1], 48
    s_load_dwordx4 s[48:51], s[0:1], 64
    s_setprio 3
    v_and_b32 v32, 15, v0
    v_lshrrev_b32 v33, 4, v0
    s_lshl_b32 s29, s22, 19
    s_lshl_b32 s30, s21, 8
    s_add_u32 s29, s29, s30
    v_lshlrev_b32 v34, 17, v33
    v_lshl_add_u32 v34, v32, 4, v34
    v_add_u32 v34, s29, v34
    v_lshlrev_b32 v35, 4, v0
    v_mov_b32 v36, 0
    s_waitcnt lgkmcnt(0)
    s_mov_b32 s12, s24
    s_mov_b32 s13, s25
    s_mov_b32 s14, 0x200000
    s_mov_b32 s15, 0x20000
    s_mov_b32 s8, s4
    s_mov_b32 s9, s5
    s_mov_b32 s10, 1024
    s_mov_b32 s11, 0x20000
    s_mov_b32 s16, s36
    s_mov_b32 s17, s37
    s_mov_b32 s18, 4194304
    s_mov_b32 s19, 0x20000
    buffer_load_dwordx4 v[8:11], v35, s[8:11], 0 offen
    buffer_load_dwordx2 v[2:3], v36, s[12:15], 0 offen sc1
    s_mov_b32 s29, 0
    buffer_load_dwordx4 v[64:67], v34, s[16:19], s29 offen nt
    s_mov_b32 s29, 8192
    buffer_load_dwordx4 v[68:71], v34, s[16:19], s29 offen nt
    s_mov_b32 s29, 16384
    buffer_load_dwordx4 v[72:75], v34, s[16:19], s29 offen nt
    s_mov_b32 s29, 24576
    buffer_load_dwordx4 v[76:79], v34, s[16:19], s29 offen nt
    s_mov_b32 s29, 32768
    buffer_load_dwordx4 v[80:83], v34, s[16:19], s29 offen nt
    s_mov_b32 s29, 40960
    buffer_load_dwordx4 v[84:87], v34, s[16:19], s29 offen nt
    s_mov_b32 s29, 49152
    buffer_load_dwordx4 v[88:91], v34, s[16:19], s29 offen nt
    s_mov_b32 s29, 57344
    buffer_load_dwordx4 v[92:95], v34, s[16:19], s29 offen nt
    s_mov_b32 s29, 65536
    buffer_load_dwordx4 v[96:99], v34, s[16:19], s29 offen nt
    s_mov_b32 s29, 73728
    buffer_load_dwordx4 v[100:103], v34, s[16:19], s29 offen nt
    s_mov_b32 s29, 81920
    buffer_load_dwordx4 v[104:107], v34, s[16:19], s29 offen nt
    s_mov_b32 s29, 90112
    buffer_load_dwordx4 v[108:111], v34, s[16:19], s29 offen nt
    s_mov_b32 s29, 98304
    buffer_load_dwordx4 v[112:115], v34, s[16:19], s29 offen nt
    s_mov_b32 s29, 106496
    buffer_load_dwordx4 v[116:119], v34, s[16:19], s29 offen nt
    s_mov_b32 s29, 114688
    buffer_load_dwordx4 v[120:123], v34, s[16:19], s29 offen nt
    s_mov_b32 s29, 122880
    buffer_load_dwordx4 v[124:127], v34, s[16:19], s29 offen nt
    s_barrier
    s_cmp_ge_u32 s22, 4
    s_cbranch_scc1 L_nozero
    s_mov_b32 s29, 393216
    s_bfe_u32 s33, s21, 0x10000
    s_lshl_b32 s33, s33, 12
    s_add_u32 s29, s29, s33
    s_bfe_u32 s33, s21, 0x10001
    s_lshl_b32 s33, s33, 13
    s_add_u32 s29, s29, s33
    s_bfe_u32 s33, s21, 0x10002
    s_lshl_b32 s33, s33, 14
    s_add_u32 s29, s29, s33
    s_bfe_u32 s33, s21, 0x10003
    s_lshl_b32 s33, s33, 8
    s_add_u32 s29, s29, s33
    s_bfe_u32 s33, s21, 0x10004
    s_lshl_b32 s33, s33, 9
    s_add_u32 s29, s29, s33
    s_bfe_u32 s33, s22, 0x10000
    s_lshl_b32 s33, s33, 10
    s_bfe_u32 s30, s22, 0x10001
    s_lshl_b32 s30, s30, 11
    s_add_u32 s33, s33, s30
    s_add_u32 s29, s29, s33
    s_mov_b64 exec, 1
    buffer_store_dword v36, v36, s[12:15], s29 offen sc1
    s_mov_b64 exec, -1
L_nozero:
    v_lshlrev_b32 v37, 2, v0
    v_mov_b32 v38, -1
    ds_write_b32 v37, v38 offset:5120
    ds_write_b32 v37, v38 offset:5376
    ds_write_b32 v37, v38 offset:5632
    ds_write_b32 v37, v36 offset:5888
    v_and_b32 v37, 1, v32
    v_mov_b32 v38, 0xffff
    v_mov_b32 v39, 0xffff0000
    v_cmp_eq_u32 vcc, 1, v37
    v_lshrrev_b32 v40, 1, v32
    v_and_b32 v41, 3, v40
    v_cndmask_b32 v38, v38, v39, vcc
    v_cmp_eq_u32 vcc, 0, v40
    s_nop 1
    v_cndmask_b32 v20, 0, v38, vcc
    v_cmp_eq_u32 vcc, 0, v41
    s_nop 1
    v_cndmask_b32 v24, 0, v38, vcc
    v_cmp_eq_u32 vcc, 1, v40
    s_nop 1
    v_cndmask_b32 v21, 0, v38, vcc
    v_cmp_eq_u32 vcc, 1, v41
    s_nop 1
    v_cndmask_b32 v25, 0, v38, vcc
    v_cmp_eq_u32 vcc, 2, v40
    s_nop 1
    v_cndmask_b32 v22, 0, v38, vcc
    v_cmp_eq_u32 vcc, 2, v41
    s_nop 1
    v_cndmask_b32 v26, 0, v38, vcc
    v_cmp_eq_u32 vcc, 3, v40
    s_nop 1
    v_cndmask_b32 v23, 0, v38, vcc
    v_cmp_eq_u32 vcc, 3, v41
    s_nop 1
    v_cndmask_b32 v27, 0, v38, vcc
    s_waitcnt vmcnt(16)
    v_lshlrev_b32 v12, 16, v8
    v_and_b32 v13, 0xffff0000, v8
    v_lshlrev_b32 v14, 16, v9
    v_and_b32 v15, 0xffff0000, v9
    v_lshlrev_b32 v16, 16, v10
    v_and_b32 v17, 0xffff0000, v10
    v_lshlrev_b32 v18, 16, v11
    v_and_b32 v19, 0xffff0000, v11
    v_add_co_u32 v4, vcc, 1, v2
    s_nop 1
    v_addc_co_u32 v5, vcc, 0, v3, vcc
    v_add_f32 v42, v12, v13
    v_add_f32 v42, v42, v14
    v_add_f32 v42, v42, v15
    v_add_f32 v42, v42, v16
    v_add_f32 v42, v42, v17
    v_add_f32 v42, v42, v18
    v_add_f32 v42, v42, v19
    s_nop 1
    v_add_f32_dpp v42, v42, v42 row_ror:8 row_mask:0xf bank_mask:0xf
    s_nop 1
    v_add_f32_dpp v42, v42, v42 row_ror:4 row_mask:0xf bank_mask:0xf
    s_nop 1
    v_add_f32_dpp v42, v42, v42 row_ror:2 row_mask:0xf bank_mask:0xf
    s_nop 1
    v_add_f32_dpp v42, v42, v42 row_ror:1 row_mask:0xf bank_mask:0xf
    v_mov_b32 v43, v42
    s_nop 1
    v_permlane16_swap_b32 v42, v43
    v_add_f32 v42, v42, v43
    v_mov_b32 v43, v42
    s_nop 1
    v_permlane32_swap_b32 v42, v43
    v_add_f32 v42, v42, v43
    v_mul_f32 v42, 0x3b000000, v42
    v_sub_f32 v44, v12, v42
    v_mul_f32 v45, v44, v44
    v_sub_f32 v44, v13, v42
    v_fmac_f32 v45, v44, v44
    v_sub_f32 v44, v14, v42
    v_fmac_f32 v45, v44, v44
    v_sub_f32 v44, v15, v42
    v_fmac_f32 v45, v44, v44
    v_sub_f32 v44, v16, v42
    v_fmac_f32 v45, v44, v44
    v_sub_f32 v44, v17, v42
    v_fmac_f32 v45, v44, v44
    v_sub_f32 v44, v18, v42
    v_fmac_f32 v45, v44, v44
    v_sub_f32 v44, v19, v42
    v_fmac_f32 v45, v44, v44
    s_nop 1
    v_add_f32_dpp v45, v45, v45 row_ror:8 row_mask:0xf bank_mask:0xf
    s_nop 1
    v_add_f32_dpp v45, v45, v45 row_ror:4 row_mask:0xf bank_mask:0xf
    s_nop 1
    v_add_f32_dpp v45, v45, v45 row_ror:2 row_mask:0xf bank_mask:0xf
    s_nop 1
    v_add_f32_dpp v45, v45, v45 row_ror:1 row_mask:0xf bank_mask:0xf
    v_mov_b32 v43, v45
    s_nop 1
    v_permlane16_swap_b32 v45, v43
    v_add_f32 v45, v45, v43
    v_mov_b32 v43, v45
    s_nop 1
    v_permlane32_swap_b32 v45, v43
    v_add_f32 v45, v45, v43
    v_mul_f32 v45, 0x3b000000, v45
    v_cvt_pk_bf16_f32 v42, v42, v42
    v_and_b32 v42, 0xffff0000, v42
    v_cvt_pk_bf16_f32 v45, v45, v45
    v_and_b32 v45, 0xffff0000, v45
    v_add_f32 v45, 0x3727c5ac, v45
    v_cvt_pk_bf16_f32 v45, v45, v45
    v_and_b32 v45, 0xffff0000, v45
    v_sqrt_f32 v45, v45
    s_nop 0
    v_cvt_pk_bf16_f32 v45, v45, v45
    v_and_b32 v45, 0xffff0000, v45
    v_rcp_f32 v46, v45
    v_sub_f32 v12, v12, v42
    v_cvt_pk_bf16_f32 v12, v12, v12
    v_and_b32 v12, 0xffff0000, v12
    v_mul_f32 v44, v12, v46
    v_fma_f32 v47, -v44, v45, v12
    v_fma_f32 v44, v47, v46, v44
    v_cvt_pk_bf16_f32 v12, v44, v44
    v_and_b32 v12, 0xffff0000, v12
    v_sub_f32 v13, v13, v42
    v_cvt_pk_bf16_f32 v13, v13, v13
    v_and_b32 v13, 0xffff0000, v13
    v_mul_f32 v44, v13, v46
    v_fma_f32 v47, -v44, v45, v13
    v_fma_f32 v44, v47, v46, v44
    v_cvt_pk_bf16_f32 v13, v44, v44
    v_and_b32 v13, 0xffff0000, v13
    v_sub_f32 v14, v14, v42
    v_cvt_pk_bf16_f32 v14, v14, v14
    v_and_b32 v14, 0xffff0000, v14
    v_mul_f32 v44, v14, v46
    v_fma_f32 v47, -v44, v45, v14
    v_fma_f32 v44, v47, v46, v44
    v_cvt_pk_bf16_f32 v14, v44, v44
    v_and_b32 v14, 0xffff0000, v14
    v_sub_f32 v15, v15, v42
    v_cvt_pk_bf16_f32 v15, v15, v15
    v_and_b32 v15, 0xffff0000, v15
    v_mul_f32 v44, v15, v46
    v_fma_f32 v47, -v44, v45, v15
    v_fma_f32 v44, v47, v46, v44
    v_cvt_pk_bf16_f32 v15, v44, v44
    v_and_b32 v15, 0xffff0000, v15
    v_sub_f32 v16, v16, v42
    v_cvt_pk_bf16_f32 v16, v16, v16
    v_and_b32 v16, 0xffff0000, v16
    v_mul_f32 v44, v16, v46
    v_fma_f32 v47, -v44, v45, v16
    v_fma_f32 v44, v47, v46, v44
    v_cvt_pk_bf16_f32 v16, v44, v44
    v_and_b32 v16, 0xffff0000, v16
    v_sub_f32 v17, v17, v42
    v_cvt_pk_bf16_f32 v17, v17, v17
    v_and_b32 v17, 0xffff0000, v17
    v_mul_f32 v44, v17, v46
    v_fma_f32 v47, -v44, v45, v17
    v_fma_f32 v44, v47, v46, v44
    v_cvt_pk_bf16_f32 v17, v44, v44
    v_and_b32 v17, 0xffff0000, v17
    v_sub_f32 v18, v18, v42
    v_cvt_pk_bf16_f32 v18, v18, v18
    v_and_b32 v18, 0xffff0000, v18
    v_mul_f32 v44, v18, v46
    v_fma_f32 v47, -v44, v45, v18
    v_fma_f32 v44, v47, v46, v44
    v_cvt_pk_bf16_f32 v18, v44, v44
    v_and_b32 v18, 0xffff0000, v18
    v_sub_f32 v19, v19, v42
    v_cvt_pk_bf16_f32 v19, v19, v19
    v_and_b32 v19, 0xffff0000, v19
    v_mul_f32 v44, v19, v46
    v_fma_f32 v47, -v44, v45, v19
    v_fma_f32 v44, v47, v46, v44
    v_cvt_pk_bf16_f32 v19, v44, v44
    v_and_b32 v19, 0xffff0000, v19
    v_lshlrev_b32 v44, 5, v0
    ds_write_b128 v44, v[12:15] offset:0
    ds_write_b128 v44, v[16:19] offset:16
    s_lshl_b32 s29, s22, 8
    v_lshlrev_b32 v44, 6, v33
    v_add_u32 v44, s29, v44
    s_waitcnt lgkmcnt(0)
    ds_read_b128 v[128:131], v44 offset:0
    ds_read_b128 v[132:135], v44 offset:16
    ds_read_b128 v[136:139], v44 offset:32
    ds_read_b128 v[140:143], v44 offset:48
    s_waitcnt lgkmcnt(0)
    v_cvt_pk_bf16_f32 v128, v128, v128
    v_cvt_pk_bf16_f32 v129, v129, v129
    v_cvt_pk_bf16_f32 v130, v130, v130
    v_cvt_pk_bf16_f32 v131, v131, v131
    v_cvt_pk_bf16_f32 v132, v132, v132
    v_cvt_pk_bf16_f32 v133, v133, v133
    v_cvt_pk_bf16_f32 v134, v134, v134
    v_cvt_pk_bf16_f32 v135, v135, v135
    v_cvt_pk_bf16_f32 v136, v136, v136
    v_cvt_pk_bf16_f32 v137, v137, v137
    v_cvt_pk_bf16_f32 v138, v138, v138
    v_cvt_pk_bf16_f32 v139, v139, v139
    v_cvt_pk_bf16_f32 v140, v140, v140
    v_cvt_pk_bf16_f32 v141, v141, v141
    v_cvt_pk_bf16_f32 v142, v142, v142
    v_cvt_pk_bf16_f32 v143, v143, v143
    s_waitcnt vmcnt(0)
    v_and_b32 v144, v128, v20
    v_and_b32 v145, v128, v21
    v_and_b32 v146, v128, v22
    v_and_b32 v147, v128, v23
    s_nop 1
    v_mfma_f32_16x16x32_bf16 v[28:31], v[144:147], v[64:67], 0
    v_and_b32 v148, v129, v20
    v_and_b32 v149, v129, v21
    v_and_b32 v150, v129, v22
    v_and_b32 v151, v129, v23
    s_nop 1
    v_mfma_f32_16x16x32_bf16 v[28:31], v[148:151], v[68:71], v[28:31]
    v_and_b32 v144, v130, v20
    v_and_b32 v145, v130, v21
    v_and_b32 v146, v130, v22
    v_and_b32 v147, v130, v23
    s_nop 1
    v_mfma_f32_16x16x32_bf16 v[28:31], v[144:147], v[72:75], v[28:31]
    v_and_b32 v148, v131, v20
    v_and_b32 v149, v131, v21
    v_and_b32 v150, v131, v22
    v_and_b32 v151, v131, v23
    s_nop 1
    v_mfma_f32_16x16x32_bf16 v[28:31], v[148:151], v[76:79], v[28:31]
    v_and_b32 v144, v132, v20
    v_and_b32 v145, v132, v21
    v_and_b32 v146, v132, v22
    v_and_b32 v147, v132, v23
    s_nop 1
    v_mfma_f32_16x16x32_bf16 v[28:31], v[144:147], v[80:83], v[28:31]
    v_and_b32 v148, v133, v20
    v_and_b32 v149, v133, v21
    v_and_b32 v150, v133, v22
    v_and_b32 v151, v133, v23
    s_nop 1
    v_mfma_f32_16x16x32_bf16 v[28:31], v[148:151], v[84:87], v[28:31]
    v_and_b32 v144, v134, v20
    v_and_b32 v145, v134, v21
    v_and_b32 v146, v134, v22
    v_and_b32 v147, v134, v23
    s_nop 1
    v_mfma_f32_16x16x32_bf16 v[28:31], v[144:147], v[88:91], v[28:31]
    v_and_b32 v148, v135, v20
    v_and_b32 v149, v135, v21
    v_and_b32 v150, v135, v22
    v_and_b32 v151, v135, v23
    s_nop 1
    v_mfma_f32_16x16x32_bf16 v[28:31], v[148:151], v[92:95], v[28:31]
    v_and_b32 v144, v136, v20
    v_and_b32 v145, v136, v21
    v_and_b32 v146, v136, v22
    v_and_b32 v147, v136, v23
    s_nop 1
    v_mfma_f32_16x16x32_bf16 v[28:31], v[144:147], v[96:99], v[28:31]
    v_and_b32 v148, v137, v20
    v_and_b32 v149, v137, v21
    v_and_b32 v150, v137, v22
    v_and_b32 v151, v137, v23
    s_nop 1
    v_mfma_f32_16x16x32_bf16 v[28:31], v[148:151], v[100:103], v[28:31]
    v_and_b32 v144, v138, v20
    v_and_b32 v145, v138, v21
    v_and_b32 v146, v138, v22
    v_and_b32 v147, v138, v23
    s_nop 1
    v_mfma_f32_16x16x32_bf16 v[28:31], v[144:147], v[104:107], v[28:31]
    v_and_b32 v148, v139, v20
    v_and_b32 v149, v139, v21
    v_and_b32 v150, v139, v22
    v_and_b32 v151, v139, v23
    s_nop 1
    v_mfma_f32_16x16x32_bf16 v[28:31], v[148:151], v[108:111], v[28:31]
    v_and_b32 v144, v140, v20
    v_and_b32 v145, v140, v21
    v_and_b32 v146, v140, v22
    v_and_b32 v147, v140, v23
    s_nop 1
    v_mfma_f32_16x16x32_bf16 v[28:31], v[144:147], v[112:115], v[28:31]
    v_and_b32 v148, v141, v20
    v_and_b32 v149, v141, v21
    v_and_b32 v150, v141, v22
    v_and_b32 v151, v141, v23
    s_nop 1
    v_mfma_f32_16x16x32_bf16 v[28:31], v[148:151], v[116:119], v[28:31]
    v_and_b32 v144, v142, v20
    v_and_b32 v145, v142, v21
    v_and_b32 v146, v142, v22
    v_and_b32 v147, v142, v23
    s_nop 1
    v_mfma_f32_16x16x32_bf16 v[28:31], v[144:147], v[120:123], v[28:31]
    v_and_b32 v148, v143, v20
    v_and_b32 v149, v143, v21
    v_and_b32 v150, v143, v22
    v_and_b32 v151, v143, v23
    s_nop 1
    v_mfma_f32_16x16x32_bf16 v[28:31], v[148:151], v[124:127], v[28:31]
    s_lshl_b32 s29, s2, 10
    s_add_u32 s29, s29, 65536
    v_and_b32 v44, 1, v33
    v_lshlrev_b32 v44, 5, v44
    v_lshrrev_b32 v45, 1, v33
    v_lshl_add_u32 v44, v45, 4, v44
    v_lshl_add_u32 v6, v32, 6, v44
    s_nop 3
    v_permlane32_swap_b32 v28, v30
    v_permlane32_swap_b32 v29, v31
    v_mov_b32 v50, v4
    v_mov_b32 v51, v5
    v_mov_b32 v48, v28
    v_mov_b32 v49, v29
    buffer_store_dwordx4 v[48:51], v6, s[12:15], s29 offen sc1
    s_lshl_b32 s29, s21, 13
    s_add_u32 s29, s29, 65536
    s_mov_b32 s34, 400000
L_pq:
    s_add_u32 s33, s29, 0
    buffer_load_dwordx4 v[64:67], v35, s[12:15], s33 offen sc1
    s_add_u32 s33, s29, 1024
    buffer_load_dwordx4 v[68:71], v35, s[12:15], s33 offen sc1
    s_add_u32 s33, s29, 2048
    buffer_load_dwordx4 v[72:75], v35, s[12:15], s33 offen sc1
    s_add_u32 s33, s29, 3072
    buffer_load_dwordx4 v[76:79], v35, s[12:15], s33 offen sc1
    s_add_u32 s33, s29, 4096
    buffer_load_dwordx4 v[80:83], v35, s[12:15], s33 offen sc1
    s_add_u32 s33, s29, 5120
    buffer_load_dwordx4 v[84:87], v35, s[12:15], s33 offen sc1
    s_add_u32 s33, s29, 6144
    buffer_load_dwordx4 v[88:91], v35, s[12:15], s33 offen sc1
    s_add_u32 s33, s29, 7168
    buffer_load_dwordx4 v[92:95], v35, s[12:15], s33 offen sc1
    s_waitcnt vmcnt(0)
    s_mov_b64 s[30:31], -1
    v_cmp_eq_u64 vcc, v[66:67], v[4:5]
    s_and_b64 s[30:31], s[30:31], vcc
    v_cmp_eq_u64 vcc, v[70:71], v[4:5]
    s_and_b64 s[30:31], s[30:31], vcc
    v_cmp_eq_u64 vcc, v[74:75], v[4:5]
    s_and_b64 s[30:31], s[30:31], vcc
    v_cmp_eq_u64 vcc, v[78:79], v[4:5]
    s_and_b64 s[30:31], s[30:31], vcc
    v_cmp_eq_u64 vcc, v[82:83], v[4:5]
    s_and_b64 s[30:31], s[30:31], vcc
    v_cmp_eq_u64 vcc, v[86:87], v[4:5]
    s_and_b64 s[30:31], s[30:31], vcc
    v_cmp_eq_u64 vcc, v[90:91], v[4:5]
    s_and_b64 s[30:31], s[30:31], vcc
    v_cmp_eq_u64 vcc, v[94:95], v[4:5]
    s_and_b64 s[30:31], s[30:31], vcc
    s_cmp_eq_u64 s[30:31], -1
    s_cbranch_scc1 L_pq_ok
    s_sub_u32 s34, s34, 1
    s_cmp_lg_u32 s34, 0
    s_cbranch_scc1 L_pq
L_pq_ok:
    v_add_f32 v44, v64, v68
    v_add_f32 v45, v65, v69
    v_add_f32 v44, v44, v72
    v_add_f32 v45, v45, v73
    v_add_f32 v44, v44, v76
    v_add_f32 v45, v45, v77
    v_add_f32 v44, v44, v80
    v_add_f32 v45, v45, v81
    v_add_f32 v44, v44, v84
    v_add_f32 v45, v45, v85
    v_add_f32 v44, v44, v88
    v_add_f32 v45, v45, v89
    v_add_f32 v44, v44, v92
    v_add_f32 v45, v45, v93
    v_cvt_pk_bf16_f32 v44, v44, v45
    v_lshlrev_b32 v45, 2, v0
    ds_write_b32 v45, v44 offset:2048
    s_waitcnt lgkmcnt(0)
    s_barrier
    s_setprio 0
    s_and_b32 s29, s2, 7
    s_lshl_b32 s29, s29, 1
    s_bfe_u32 s30, s2, 0x10003
    s_or_b32 s58, s29, s30
    s_lshr_b32 s59, s2, 4
    s_cmp_ge_u32 s58, 11
    s_cbranch_scc1 L_nos1
    s_mov_b32 s8, s44
    s_mov_b32 s9, s45
    s_mov_b32 s10, 1409024
    s_mov_b32 s11, 0x20000
    s_mov_b32 s16, s46
    s_mov_b32 s17, s47
    s_mov_b32 s18, 1409024
    s_mov_b32 s19, 0x20000
    s_and_b32 s31, s59, 1
    s_lshr_b32 s30, s59, 1
    s_lshl_b32 s30, s30, 6
    s_add_u32 s30, s30, s31
    v_lshlrev_b32 v44, 4, v33
    v_add_u32 v44, s30, v44
    v_lshlrev_b32 v47, 2, v44
    v_mul_u32_u24 v44, 2752, v44
    v_lshl_add_u32 v44, v32, 4, v44
    s_lshl_b32 s33, s58, 7
    s_lshl_b32 s34, s31, 5
    s_sub_u32 s33, s33, s34
    v_lshlrev_b32 v45, 3, v32
    v_add_u32 v45, s33, v45
    s_lshl_b32 s33, s33, 1
    v_add_u32 v44, s33, v44
    v_mov_b32 v46, 0x7ffffff0
    v_cmp_gt_u32 vcc, 1376, v45
    s_nop 1
    v_cndmask_b32 v44, v46, v44, vcc
    s_mov_b32 s33, 0
    buffer_load_dwordx4 v[64:67], v44, s[8:11], s33 offen nt
    buffer_load_dwordx4 v[96:99], v44, s[16:19], s33 offen nt
    s_mov_b32 s33, 5504
    buffer_load_dwordx4 v[68:71], v44, s[8:11], s33 offen nt
    buffer_load_dwordx4 v[100:103], v44, s[16:19], s33 offen nt
    s_mov_b32 s33, 11008
    buffer_load_dwordx4 v[72:75], v44, s[8:11], s33 offen nt
    buffer_load_dwordx4 v[104:107], v44, s[16:19], s33 offen nt
    s_mov_b32 s33, 16512
    buffer_load_dwordx4 v[76:79], v44, s[8:11], s33 offen nt
    buffer_load_dwordx4 v[108:111], v44, s[16:19], s33 offen nt
    s_mov_b32 s33, 22016
    buffer_load_dwordx4 v[80:83], v44, s[8:11], s33 offen nt
    buffer_load_dwordx4 v[112:115], v44, s[16:19], s33 offen nt
    s_mov_b32 s33, 27520
    buffer_load_dwordx4 v[84:87], v44, s[8:11], s33 offen nt
    buffer_load_dwordx4 v[116:119], v44, s[16:19], s33 offen nt
    s_mov_b32 s33, 33024
    buffer_load_dwordx4 v[88:91], v44, s[8:11], s33 offen nt
    buffer_load_dwordx4 v[120:123], v44, s[16:19], s33 offen nt
    s_mov_b32 s33, 38528
    buffer_load_dwordx4 v[92:95], v44, s[8:11], s33 offen nt
    buffer_load_dwordx4 v[124:127], v44, s[16:19], s33 offen nt
    ds_read2_b32 v[128:129], v47 offset0:0 offset1:2
    ds_read2_b32 v[130:131], v47 offset0:4 offset1:6
    ds_read2_b32 v[132:133], v47 offset0:8 offset1:10
    ds_read2_b32 v[134:135], v47 offset0:12 offset1:14
    v_xor_b32 v24, v24, v20
    v_xor_b32 v25, v25, v21
    v_xor_b32 v26, v26, v22
    v_xor_b32 v27, v27, v23
    v_and_b32 v45, 1, v33
    v_lshlrev_b32 v45, 5, v45
    v_lshrrev_b32 v46, 1, v33
    v_lshl_add_u32 v45, v46, 4, v45
    v_and_b32 v46, 3, v32
    v_lshl_add_u32 v45, v46, 6, v45
    v_lshrrev_b32 v46, 2, v32
    v_lshl_add_u32 v45, v46, 9, v45
    s_mul_i32 s29, s59, 22528
    s_lshl_b32 s30, s58, 11
    s_add_u32 s29, s29, s30
    s_add_u32 s29, s29, 1703936
    s_waitcnt lgkmcnt(0)
    v_cvt_pk_bf16_f32 v128, v128, v128
    v_cvt_pk_bf16_f32 v129, v129, v129
    v_cvt_pk_bf16_f32 v130, v130, v130
    v_cvt_pk_bf16_f32 v131, v131, v131
    v_cvt_pk_bf16_f32 v132, v132, v132
    v_cvt_pk_bf16_f32 v133, v133, v133
    v_cvt_pk_bf16_f32 v134, v134, v134
    v_cvt_pk_bf16_f32 v135, v135, v135
    s_waitcnt vmcnt(0)
    v_and_b32 v144, v128, v20
    v_and_b32 v145, v128, v21
    v_and_b32 v146, v128, v22
    v_and_b32 v147, v128, v23
    s_nop 1
    v_mfma_f32_16x16x32_bf16 v[28:31], v[144:147], v[64:67], 0
    v_and_b32 v148, v128, v24
    v_and_b32 v149, v128, v25
    v_and_b32 v150, v128, v26
    v_and_b32 v151, v128, v27
    s_nop 1
    v_mfma_f32_16x16x32_bf16 v[28:31], v[148:151], v[96:99], v[28:31]
    v_and_b32 v144, v129, v20
    v_and_b32 v145, v129, v21
    v_and_b32 v146, v129, v22
    v_and_b32 v147, v129, v23
    s_nop 1
    v_mfma_f32_16x16x32_bf16 v[28:31], v[144:147], v[68:71], v[28:31]
    v_and_b32 v148, v129, v24
    v_and_b32 v149, v129, v25
    v_and_b32 v150, v129, v26
    v_and_b32 v151, v129, v27
    s_nop 1
    v_mfma_f32_16x16x32_bf16 v[28:31], v[148:151], v[100:103], v[28:31]
    v_and_b32 v144, v130, v20
    v_and_b32 v145, v130, v21
    v_and_b32 v146, v130, v22
    v_and_b32 v147, v130, v23
    s_nop 1
    v_mfma_f32_16x16x32_bf16 v[28:31], v[144:147], v[72:75], v[28:31]
    v_and_b32 v148, v130, v24
    v_and_b32 v149, v130, v25
    v_and_b32 v150, v130, v26
    v_and_b32 v151, v130, v27
    s_nop 1
    v_mfma_f32_16x16x32_bf16 v[28:31], v[148:151], v[104:107], v[28:31]
    v_and_b32 v144, v131, v20
    v_and_b32 v145, v131, v21
    v_and_b32 v146, v131, v22
    v_and_b32 v147, v131, v23
    s_nop 1
    v_mfma_f32_16x16x32_bf16 v[28:31], v[144:147], v[76:79], v[28:31]
    v_and_b32 v148, v131, v24
    v_and_b32 v149, v131, v25
    v_and_b32 v150, v131, v26
    v_and_b32 v151, v131, v27
    s_nop 1
    v_mfma_f32_16x16x32_bf16 v[28:31], v[148:151], v[108:111], v[28:31]
    v_and_b32 v144, v132, v20
    v_and_b32 v145, v132, v21
    v_and_b32 v146, v132, v22
    v_and_b32 v147, v132, v23
    s_nop 1
    v_mfma_f32_16x16x32_bf16 v[28:31], v[144:147], v[80:83], v[28:31]
    v_and_b32 v148, v132, v24
    v_and_b32 v149, v132, v25
    v_and_b32 v150, v132, v26
    v_and_b32 v151, v132, v27
    s_nop 1
    v_mfma_f32_16x16x32_bf16 v[28:31], v[148:151], v[112:115], v[28:31]
    v_and_b32 v144, v133, v20
    v_and_b32 v145, v133, v21
    v_and_b32 v146, v133, v22
    v_and_b32 v147, v133, v23
    s_nop 1
    v_mfma_f32_16x16x32_bf16 v[28:31], v[144:147], v[84:87], v[28:31]
    v_and_b32 v148, v133, v24
    v_and_b32 v149, v133, v25
    v_and_b32 v150, v133, v26
    v_and_b32 v151, v133, v27
    s_nop 1
    v_mfma_f32_16x16x32_bf16 v[28:31], v[148:151], v[116:119], v[28:31]
    v_and_b32 v144, v134, v20
    v_and_b32 v145, v134, v21
    v_and_b32 v146, v134, v22
    v_and_b32 v147, v134, v23
    s_nop 1
    v_mfma_f32_16x16x32_bf16 v[28:31], v[144:147], v[88:91], v[28:31]
    v_and_b32 v148, v134, v24
    v_and_b32 v149, v134, v25
    v_and_b32 v150, v134, v26
    v_and_b32 v151, v134, v27
    s_nop 1
    v_mfma_f32_16x16x32_bf16 v[28:31], v[148:151], v[120:123], v[28:31]
    v_and_b32 v144, v135, v20
    v_and_b32 v145, v135, v21
    v_and_b32 v146, v135, v22
    v_and_b32 v147, v135, v23
    s_nop 1
    v_mfma_f32_16x16x32_bf16 v[28:31], v[144:147], v[92:95], v[28:31]
    v_and_b32 v148, v135, v24
    v_and_b32 v149, v135, v25
    v_and_b32 v150, v135, v26
    v_and_b32 v151, v135, v27
    s_nop 1
    v_mfma_f32_16x16x32_bf16 v[28:31], v[148:151], v[124:127], v[28:31]
    v_mov_b32 v50, v4
    v_mov_b32 v51, v5
    v_mov_b32 v54, v4
    v_mov_b32 v55, v5
    s_nop 7
    v_permlane32_swap_b32 v28, v29
    v_permlane32_swap_b32 v30, v31
    s_nop 1
    v_mov_b32 v48, v28
    v_mov_b32 v49, v29
    v_mov_b32 v52, v30
    v_mov_b32 v53, v31
    buffer_store_dwordx4 v[48:51], v45, s[12:15], s29 offen sc1
    buffer_store_dwordx4 v[52:55], v45, s[12:15], s29 offen offset:256 sc1
L_nos1:
    s_mov_b32 s16, s38
    s_mov_b32 s17, s39
    s_mov_b32 s18, 4194304
    s_mov_b32 s19, 0x20000
    v_lshrrev_b32 v44, 3, v0
    v_lshlrev_b32 v44, 14, v44
    v_and_b32 v45, 7, v0
    v_lshl_add_u32 v44, v45, 4, v44
    s_lshl_b32 s28, s21, 17
    s_lshl_b32 s33, s22, 7
    s_add_u32 s28, s28, s33
    s_add_u32 s33, s28, 0
    buffer_load_dwordx4 v[160:163], v44, s[16:19], s33 offen nt
    s_add_u32 s33, s28, 1024
    buffer_load_dwordx4 v[164:167], v44, s[16:19], s33 offen nt
    s_add_u32 s33, s28, 2048
    buffer_load_dwordx4 v[168:171], v44, s[16:19], s33 offen nt
    s_add_u32 s33, s28, 3072
    buffer_load_dwordx4 v[172:175], v44, s[16:19], s33 offen nt
    s_add_u32 s33, s28, 4096
    buffer_load_dwordx4 v[176:179], v44, s[16:19], s33 offen nt
    s_add_u32 s33, s28, 5120
    buffer_load_dwordx4 v[180:183], v44, s[16:19], s33 offen nt
    s_add_u32 s33, s28, 6144
    buffer_load_dwordx4 v[184:187], v44, s[16:19], s33 offen nt
    s_add_u32 s33, s28, 7168
    buffer_load_dwordx4 v[188:191], v44, s[16:19], s33 offen nt
    s_add_u32 s33, s28, 8192
    buffer_load_dwordx4 v[192:195], v44, s[16:19], s33 offen nt
    s_add_u32 s33, s28, 9216
    buffer_load_dwordx4 v[196:199], v44, s[16:19], s33 offen nt
    s_add_u32 s33, s28, 10240
    buffer_load_dwordx4 v[200:203], v44, s[16:19], s33 offen nt
    s_add_u32 s33, s28, 11264
    buffer_load_dwordx4 v[204:207], v44, s[16:19], s33 offen nt
    s_add_u32 s33, s28, 12288
    buffer_load_dwordx4 v[208:211], v44, s[16:19], s33 offen nt
    s_add_u32 s33, s28, 13312
    buffer_load_dwordx4 v[212:215], v44, s[16:19], s33 offen nt
    s_add_u32 s33, s28, 14336
    buffer_load_dwordx4 v[216:219], v44, s[16:19], s33 offen nt
    s_add_u32 s33, s28, 15360
    buffer_load_dwordx4 v[220:223], v44, s[16:19], s33 offen nt
    v_lshrrev_b32 v44, 3, v0
    v_mul_u32_u24 v44, 2304, v44
    v_and_b32 v45, 7, v0
    v_lshl_add_u32 v44, v45, 4, v44
    s_waitcnt vmcnt(0)
    ds_write_b128 v44, v[160:163] offset:8192
    ds_write_b128 v44, v[164:167] offset:8336
    ds_write_b128 v44, v[168:171] offset:8480
    ds_write_b128 v44, v[172:175] offset:8624
    ds_write_b128 v44, v[176:179] offset:8768
    ds_write_b128 v44, v[180:183] offset:8912
    ds_write_b128 v44, v[184:187] offset:9056
    ds_write_b128 v44, v[188:191] offset:9200
    s_waitcnt lgkmcnt(0)
    ds_write_b128 v44, v[192:195] offset:9344
    ds_write_b128 v44, v[196:199] offset:9488
    ds_write_b128 v44, v[200:203] offset:9632
    ds_write_b128 v44, v[204:207] offset:9776
    ds_write_b128 v44, v[208:211] offset:9920
    ds_write_b128 v44, v[212:215] offset:10064
    ds_write_b128 v44, v[216:219] offset:10208
    ds_write_b128 v44, v[220:223] offset:10352
    s_waitcnt lgkmcnt(0)
    v_mul_u32_u24 v44, 1152, v33
    v_lshl_add_u32 v44, v32, 1, v44
    ds_read_u16 v64, v44 offset:8192
    ds_read_u16 v65, v44 offset:8336
    ds_read_u16 v66, v44 offset:8480
    ds_read_u16 v67, v44 offset:8624
    ds_read_u16 v68, v44 offset:8768
    ds_read_u16 v69, v44 offset:8912
    ds_read_u16 v70, v44 offset:9056
    ds_read_u16 v71, v44 offset:9200
    s_waitcnt lgkmcnt(0)
    v_lshl_or_b32 v160, v65, 16, v64
    v_lshl_or_b32 v161, v67, 16, v66
    v_lshl_or_b32 v162, v69, 16, v68
    v_lshl_or_b32 v163, v71, 16, v70
    ds_read_u16 v64, v44 offset:12800
    ds_read_u16 v65, v44 offset:12944
    ds_read_u16 v66, v44 offset:13088
    ds_read_u16 v67, v44 offset:13232
    ds_read_u16 v68, v44 offset:13376
    ds_read_u16 v69, v44 offset:13520
    ds_read_u16 v70, v44 offset:13664
    ds_read_u16 v71, v44 offset:13808
    s_waitcnt lgkmcnt(0)
    v_lshl_or_b32 v164, v65, 16, v64
    v_lshl_or_b32 v165, v67, 16, v66
    v_lshl_or_b32 v166, v69, 16, v68
    v_lshl_or_b32 v167, v71, 16, v70
    ds_read_u16 v64, v44 offset:17408
    ds_read_u16 v65, v44 offset:17552
    ds_read_u16 v66, v44 offset:17696
    ds_read_u16 v67, v44 offset:17840
    ds_read_u16 v68, v44 offset:17984
    ds_read_u16 v69, v44 offset:18128
    ds_read_u16 v70, v44 offset:18272
    ds_read_u16 v71, v44 offset:18416
    s_waitcnt lgkmcnt(0)
    v_lshl_or_b32 v168, v65, 16, v64
    v_lshl_or_b32 v169, v67, 16, v66
    v_lshl_or_b32 v170, v69, 16, v68
    v_lshl_or_b32 v171, v71, 16, v70
    ds_read_u16 v64, v44 offset:22016
    ds_read_u16 v65, v44 offset:22160
    ds_read_u16 v66, v44 offset:22304
    ds_read_u16 v67, v44 offset:22448
    ds_read_u16 v68, v44 offset:22592
    ds_read_u16 v69, v44 offset:22736
    ds_read_u16 v70, v44 offset:22880
    ds_read_u16 v71, v44 offset:23024
    s_waitcnt lgkmcnt(0)
    v_lshl_or_b32 v172, v65, 16, v64
    v_lshl_or_b32 v173, v67, 16, v66
    v_lshl_or_b32 v174, v69, 16, v68
    v_lshl_or_b32 v175, v71, 16, v70
    ds_read_u16 v64, v44 offset:8224
    ds_read_u16 v65, v44 offset:8368
    ds_read_u16 v66, v44 offset:8512
    ds_read_u16 v67, v44 offset:8656
    ds_read_u16 v68, v44 offset:8800
    ds_read_u16 v69, v44 offset:8944
    ds_read_u16 v70, v44 offset:9088
    ds_read_u16 v71, v44 offset:9232
    s_waitcnt lgkmcnt(0)
    v_lshl_or_b32 v176, v65, 16, v64
    v_lshl_or_b32 v177, v67, 16, v66
    v_lshl_or_b32 v178, v69, 16, v68
    v_lshl_or_b32 v179, v71, 16, v70
    ds_read_u16 v64, v44 offset:12832
    ds_read_u16 v65, v44 offset:12976
    ds_read_u16 v66, v44 offset:13120
    ds_read_u16 v67, v44 offset:13264
    ds_read_u16 v68, v44 offset:13408
    ds_read_u16 v69, v44 offset:13552
    ds_read_u16 v70, v44 offset:13696
    ds_read_u16 v71, v44 offset:13840
    s_waitcnt lgkmcnt(0)
    v_lshl_or_b32 v180, v65, 16, v64
    v_lshl_or_b32 v181, v67, 16, v66
    v_lshl_or_b32 v182, v69, 16, v68
    v_lshl_or_b32 v183, v71, 16, v70
    ds_read_u16 v64, v44 offset:17440
    ds_read_u16 v65, v44 offset:17584
    ds_read_u16 v66, v44 offset:17728
    ds_read_u16 v67, v44 offset:17872
    ds_read_u16 v68, v44 offset:18016
    ds_read_u16 v69, v44 offset:18160
    ds_read_u16 v70, v44 offset:18304
    ds_read_u16 v71, v44 offset:18448
    s_waitcnt lgkmcnt(0)
    v_lshl_or_b32 v184, v65, 16, v64
    v_lshl_or_b32 v185, v67, 16, v66
    v_lshl_or_b32 v186, v69, 16, v68
    v_lshl_or_b32 v187, v71, 16, v70
    ds_read_u16 v64, v44 offset:22048
    ds_read_u16 v65, v44 offset:22192
    ds_read_u16 v66, v44 offset:22336
    ds_read_u16 v67, v44 offset:22480
    ds_read_u16 v68, v44 offset:22624
    ds_read_u16 v69, v44 offset:22768
    ds_read_u16 v70, v44 offset:22912
    ds_read_u16 v71, v44 offset:23056
    s_waitcnt lgkmcnt(0)
    v_lshl_or_b32 v188, v65, 16, v64
    v_lshl_or_b32 v189, v67, 16, v66
    v_lshl_or_b32 v190, v69, 16, v68
    v_lshl_or_b32 v191, v71, 16, v70
    ds_read_u16 v64, v44 offset:8256
    ds_read_u16 v65, v44 offset:8400
    ds_read_u16 v66, v44 offset:8544
    ds_read_u16 v67, v44 offset:8688
    ds_read_u16 v68, v44 offset:8832
    ds_read_u16 v69, v44 offset:8976
    ds_read_u16 v70, v44 offset:9120
    ds_read_u16 v71, v44 offset:9264
    s_waitcnt lgkmcnt(0)
    v_lshl_or_b32 v192, v65, 16, v64
    v_lshl_or_b32 v193, v67, 16, v66
    v_lshl_or_b32 v194, v69, 16, v68
    v_lshl_or_b32 v195, v71, 16, v70
    ds_read_u16 v64, v44 offset:12864
    ds_read_u16 v65, v44 offset:13008
    ds_read_u16 v66, v44 offset:13152
    ds_read_u16 v67, v44 offset:13296
    ds_read_u16 v68, v44 offset:13440
    ds_read_u16 v69, v44 offset:13584
    ds_read_u16 v70, v44 offset:13728
    ds_read_u16 v71, v44 offset:13872
    s_waitcnt lgkmcnt(0)
    v_lshl_or_b32 v196, v65, 16, v64
    v_lshl_or_b32 v197, v67, 16, v66
    v_lshl_or_b32 v198, v69, 16, v68
    v_lshl_or_b32 v199, v71, 16, v70
    ds_read_u16 v64, v44 offset:17472
    ds_read_u16 v65, v44 offset:17616
    ds_read_u16 v66, v44 offset:17760
    ds_read_u16 v67, v44 offset:17904
    ds_read_u16 v68, v44 offset:18048
    ds_read_u16 v69, v44 offset:18192
    ds_read_u16 v70, v44 offset:18336
    ds_read_u16 v71, v44 offset:18480
    s_waitcnt lgkmcnt(0)
    v_lshl_or_b32 v200, v65, 16, v64
    v_lshl_or_b32 v201, v67, 16, v66
    v_lshl_or_b32 v202, v69, 16, v68
    v_lshl_or_b32 v203, v71, 16, v70
    ds_read_u16 v64, v44 offset:22080
    ds_read_u16 v65, v44 offset:22224
    ds_read_u16 v66, v44 offset:22368
    ds_read_u16 v67, v44 offset:22512
    ds_read_u16 v68, v44 offset:22656
    ds_read_u16 v69, v44 offset:22800
    ds_read_u16 v70, v44 offset:22944
    ds_read_u16 v71, v44 offset:23088
    s_waitcnt lgkmcnt(0)
    v_lshl_or_b32 v204, v65, 16, v64
    v_lshl_or_b32 v205, v67, 16, v66
    v_lshl_or_b32 v206, v69, 16, v68
    v_lshl_or_b32 v207, v71, 16, v70
    ds_read_u16 v64, v44 offset:8288
    ds_read_u16 v65, v44 offset:8432
    ds_read_u16 v66, v44 offset:8576
    ds_read_u16 v67, v44 offset:8720
    ds_read_u16 v68, v44 offset:8864
    ds_read_u16 v69, v44 offset:9008
    ds_read_u16 v70, v44 offset:9152
    ds_read_u16 v71, v44 offset:9296
    s_waitcnt lgkmcnt(0)
    v_lshl_or_b32 v208, v65, 16, v64
    v_lshl_or_b32 v209, v67, 16, v66
    v_lshl_or_b32 v210, v69, 16, v68
    v_lshl_or_b32 v211, v71, 16, v70
    ds_read_u16 v64, v44 offset:12896
    ds_read_u16 v65, v44 offset:13040
    ds_read_u16 v66, v44 offset:13184
    ds_read_u16 v67, v44 offset:13328
    ds_read_u16 v68, v44 offset:13472
    ds_read_u16 v69, v44 offset:13616
    ds_read_u16 v70, v44 offset:13760
    ds_read_u16 v71, v44 offset:13904
    s_waitcnt lgkmcnt(0)
    v_lshl_or_b32 v212, v65, 16, v64
    v_lshl_or_b32 v213, v67, 16, v66
    v_lshl_or_b32 v214, v69, 16, v68
    v_lshl_or_b32 v215, v71, 16, v70
    ds_read_u16 v64, v44 offset:17504
    ds_read_u16 v65, v44 offset:17648
    ds_read_u16 v66, v44 offset:17792
    ds_read_u16 v67, v44 offset:17936
    ds_read_u16 v68, v44 offset:18080
    ds_read_u16 v69, v44 offset:18224
    ds_read_u16 v70, v44 offset:18368
    ds_read_u16 v71, v44 offset:18512
    s_waitcnt lgkmcnt(0)
    v_lshl_or_b32 v216, v65, 16, v64
    v_lshl_or_b32 v217, v67, 16, v66
    v_lshl_or_b32 v218, v69, 16, v68
    v_lshl_or_b32 v219, v71, 16, v70
    ds_read_u16 v64, v44 offset:22112
    ds_read_u16 v65, v44 offset:22256
    ds_read_u16 v66, v44 offset:22400
    ds_read_u16 v67, v44 offset:22544
    ds_read_u16 v68, v44 offset:22688
    ds_read_u16 v69, v44 offset:22832
    ds_read_u16 v70, v44 offset:22976
    ds_read_u16 v71, v44 offset:23120
    s_waitcnt lgkmcnt(0)
    v_lshl_or_b32 v220, v65, 16, v64
    v_lshl_or_b32 v221, v67, 16, v66
    v_lshl_or_b32 v222, v69, 16, v68
    v_lshl_or_b32 v223, v71, 16, v70
    s_cmp_lt_u32 s58, 11
    s_cbranch_scc1 L_noffn
    s_sub_u32 s35, s58, 11
    s_lshl_b32 s35, s35, 4
    s_add_u32 s35, s35, s59
    s_cmp_ge_u32 s35, 43
    s_cbranch_scc1 L_noffn
    v_lshrrev_b32 v44, 5, v0
    v_mul_u32_u24 v44, 23040, v44
    v_and_b32 v45, 31, v0
    v_lshl_add_u32 v44, v45, 4, v44
    s_lshl_b32 s29, s35, 9
    s_add_u32 s29, s29, 1703936
    s_mov_b32 s34, 400000
L_ps1:
    s_add_u32 s33, s29, 0
    buffer_load_dwordx4 v[64:67], v44, s[12:15], s33 offen sc1
    s_add_u32 s33, s29, 45056
    buffer_load_dwordx4 v[68:71], v44, s[12:15], s33 offen sc1
    s_add_u32 s33, s29, 90112
    buffer_load_dwordx4 v[72:75], v44, s[12:15], s33 offen sc1
    s_add_u32 s33, s29, 135168
    buffer_load_dwordx4 v[76:79], v44, s[12:15], s33 offen sc1
    s_add_u32 s33, s29, 180224
    buffer_load_dwordx4 v[80:83], v44, s[12:15], s33 offen sc1
    s_add_u32 s33, s29, 225280
    buffer_load_dwordx4 v[84:87], v44, s[12:15], s33 offen sc1
    s_add_u32 s33, s29, 270336
    buffer_load_dwordx4 v[88:91], v44, s[12:15], s33 offen sc1
    s_add_u32 s33, s29, 315392
    buffer_load_dwordx4 v[92:95], v44, s[12:15], s33 offen sc1
    s_waitcnt vmcnt(0)
    s_mov_b64 s[30:31], -1
    v_cmp_eq_u64 vcc, v[66:67], v[4:5]
    s_and_b64 s[30:31], s[30:31], vcc
    v_cmp_eq_u64 vcc, v[70:71], v[4:5]
    s_and_b64 s[30:31], s[30:31], vcc
    v_cmp_eq_u64 vcc, v[74:75], v[4:5]
    s_and_b64 s[30:31], s[30:31], vcc
    v_cmp_eq_u64 vcc, v[78:79], v[4:5]
    s_and_b64 s[30:31], s[30:31], vcc
    v_cmp_eq_u64 vcc, v[82:83], v[4:5]
    s_and_b64 s[30:31], s[30:31], vcc
    v_cmp_eq_u64 vcc, v[86:87], v[4:5]
    s_and_b64 s[30:31], s[30:31], vcc
    v_cmp_eq_u64 vcc, v[90:91], v[4:5]
    s_and_b64 s[30:31], s[30:31], vcc
    v_cmp_eq_u64 vcc, v[94:95], v[4:5]
    s_and_b64 s[30:31], s[30:31], vcc
    s_cmp_eq_u64 s[30:31], -1
    s_cbranch_scc1 L_ps1_ok
    s_sleep 8
    s_sub_u32 s34, s34, 1
    s_cmp_lg_u32 s34, 0
    s_cbranch_scc1 L_ps1
L_ps1_ok:
    v_add_f32 v12, v64, v68
    v_add_f32 v13, v65, v69
    v_add_f32 v12, v12, v72
    v_add_f32 v13, v13, v73
    v_add_f32 v12, v12, v76
    v_add_f32 v13, v13, v77
    v_add_f32 v12, v12, v80
    v_add_f32 v13, v13, v81
    v_add_f32 v12, v12, v84
    v_add_f32 v13, v13, v85
    v_add_f32 v12, v12, v88
    v_add_f32 v13, v13, v89
    v_add_f32 v12, v12, v92
    v_add_f32 v13, v13, v93
    v_mov_b32 v46, v12
    s_nop 1
    v_permlane32_swap_b32 v12, v46
    v_add_f32 v12, v12, v46
    v_mov_b32 v46, v13
    s_nop 1
    v_permlane32_swap_b32 v13, v46
    v_add_f32 v13, v13, v46
    v_cvt_pk_bf16_f32 v12, v12, v12
    v_and_b32 v12, 0xffff0000, v12
    v_mul_f32 v46, 0xbfb8aa3b, v12
    v_exp_f32 v46, v46
    s_nop 0
    v_add_f32 v46, 1.0, v46
    v_rcp_f32 v46, v46
    s_nop 0
    v_mul_f32 v12, v12, v46
    v_cvt_pk_bf16_f32 v12, v12, v12
    v_and_b32 v12, 0xffff0000, v12
    v_cvt_pk_bf16_f32 v13, v13, v13
    v_and_b32 v13, 0xffff0000, v13
    v_mul_f32 v12, v12, v13
    v_cvt_pk_bf16_f32 v12, v12, v12
    v_and_b32 v12, 0xffff0000, v12
    v_bfe_u32 v46, v45, 2, 2
    v_lshlrev_b32 v46, 3, v46
    v_bfe_u32 v47, v45, 1, 1
    v_lshl_add_u32 v46, v47, 2, v46
    v_lshrrev_b32 v47, 4, v45
    v_lshl_add_u32 v46, v47, 1, v46
    v_and_b32 v47, 1, v45
    v_add_u32 v46, v46, v47
    v_lshlrev_b32 v45, 2, v46
    ds_write_b32 v45, v12 offset:4480
    s_mov_b32 s8, s48
    s_mov_b32 s9, s49
    s_mov_b32 s10, 1409024
    s_mov_b32 s11, 0x20000
    s_lshl_b32 s31, s35, 15
    v_mov_b32 v47, 4480
    v_mov_b32 v56, 0
    v_mov_b32 v57, 0
    v_mov_b32 v58, 0
    v_mov_b32 v59, 0
    v_mov_b32 v60, 0
    v_mov_b32 v61, 0
    v_mov_b32 v62, 0
    v_mov_b32 v63, 0
    s_mov_b32 s32, 4
    s_waitcnt lgkmcnt(0)
L_f2:
    s_add_u32 s33, s31, 0
    buffer_load_dwordx4 v[64:67], v35, s[8:11], s33 offen nt
    s_add_u32 s33, s31, 1024
    buffer_load_dwordx4 v[68:71], v35, s[8:11], s33 offen nt
    s_add_u32 s33, s31, 2048
    buffer_load_dwordx4 v[72:75], v35, s[8:11], s33 offen nt
    s_add_u32 s33, s31, 3072
    buffer_load_dwordx4 v[76:79], v35, s[8:11], s33 offen nt
    s_add_u32 s33, s31, 4096
    buffer_load_dwordx4 v[80:83], v35, s[8:11], s33 offen nt
    s_add_u32 s33, s31, 5120
    buffer_load_dwordx4 v[84:87], v35, s[8:11], s33 offen nt
    s_add_u32 s33, s31, 6144
    buffer_load_dwordx4 v[88:91], v35, s[8:11], s33 offen nt
    s_add_u32 s33, s31, 7168
    buffer_load_dwordx4 v[92:95], v35, s[8:11], s33 offen nt
    ds_read_b128 v[128:131], v47
    ds_read_b128 v[132:135], v47 offset:16
    v_add_u32 v47, 32, v47
    s_add_u32 s31, s31, 8192
    s_waitcnt vmcnt(0) lgkmcnt(0)
    v_lshlrev_b32 v44, 16, v64
    v_and_b32 v45, 0xffff0000, v64
    v_fmac_f32 v56, v44, v128
    v_fmac_f32 v57, v45, v128
    v_lshlrev_b32 v44, 16, v65
    v_and_b32 v45, 0xffff0000, v65
    v_fmac_f32 v58, v44, v128
    v_fmac_f32 v59, v45, v128
    v_lshlrev_b32 v44, 16, v66
    v_and_b32 v45, 0xffff0000, v66
    v_fmac_f32 v60, v44, v128
    v_fmac_f32 v61, v45, v128
    v_lshlrev_b32 v44, 16, v67
    v_and_b32 v45, 0xffff0000, v67
    v_fmac_f32 v62, v44, v128
    v_fmac_f32 v63, v45, v128
    v_lshlrev_b32 v44, 16, v68
    v_and_b32 v45, 0xffff0000, v68
    v_fmac_f32 v56, v44, v129
    v_fmac_f32 v57, v45, v129
    v_lshlrev_b32 v44, 16, v69
    v_and_b32 v45, 0xffff0000, v69
    v_fmac_f32 v58, v44, v129
    v_fmac_f32 v59, v45, v129
    v_lshlrev_b32 v44, 16, v70
    v_and_b32 v45, 0xffff0000, v70
    v_fmac_f32 v60, v44, v129
    v_fmac_f32 v61, v45, v129
    v_lshlrev_b32 v44, 16, v71
    v_and_b32 v45, 0xffff0000, v71
    v_fmac_f32 v62, v44, v129
    v_fmac_f32 v63, v45, v129
    v_lshlrev_b32 v44, 16, v72
    v_and_b32 v45, 0xffff0000, v72
    v_fmac_f32 v56, v44, v130
    v_fmac_f32 v57, v45, v130
    v_lshlrev_b32 v44, 16, v73
    v_and_b32 v45, 0xffff0000, v73
    v_fmac_f32 v58, v44, v130
    v_fmac_f32 v59, v45, v130
    v_lshlrev_b32 v44, 16, v74
    v_and_b32 v45, 0xffff0000, v74
    v_fmac_f32 v60, v44, v130
    v_fmac_f32 v61, v45, v130
    v_lshlrev_b32 v44, 16, v75
    v_and_b32 v45, 0xffff0000, v75
    v_fmac_f32 v62, v44, v130
    v_fmac_f32 v63, v45, v130
    v_lshlrev_b32 v44, 16, v76
    v_and_b32 v45, 0xffff0000, v76
    v_fmac_f32 v56, v44, v131
    v_fmac_f32 v57, v45, v131
    v_lshlrev_b32 v44, 16, v77
    v_and_b32 v45, 0xffff0000, v77
    v_fmac_f32 v58, v44, v131
    v_fmac_f32 v59, v45, v131
    v_lshlrev_b32 v44, 16, v78
    v_and_b32 v45, 0xffff0000, v78
    v_fmac_f32 v60, v44, v131
    v_fmac_f32 v61, v45, v131
    v_lshlrev_b32 v44, 16, v79
    v_and_b32 v45, 0xffff0000, v79
    v_fmac_f32 v62, v44, v131
    v_fmac_f32 v63, v45, v131
    v_lshlrev_b32 v44, 16, v80
    v_and_b32 v45, 0xffff0000, v80
    v_fmac_f32 v56, v44, v132
    v_fmac_f32 v57, v45, v132
    v_lshlrev_b32 v44, 16, v81
    v_and_b32 v45, 0xffff0000, v81
    v_fmac_f32 v58, v44, v132
    v_fmac_f32 v59, v45, v132
    v_lshlrev_b32 v44, 16, v82
    v_and_b32 v45, 0xffff0000, v82
    v_fmac_f32 v60, v44, v132
    v_fmac_f32 v61, v45, v132
    v_lshlrev_b32 v44, 16, v83
    v_and_b32 v45, 0xffff0000, v83
    v_fmac_f32 v62, v44, v132
    v_fmac_f32 v63, v45, v132
    v_lshlrev_b32 v44, 16, v84
    v_and_b32 v45, 0xffff0000, v84
    v_fmac_f32 v56, v44, v133
    v_fmac_f32 v57, v45, v133
    v_lshlrev_b32 v44, 16, v85
    v_and_b32 v45, 0xffff0000, v85
    v_fmac_f32 v58, v44, v133
    v_fmac_f32 v59, v45, v133
    v_lshlrev_b32 v44, 16, v86
    v_and_b32 v45, 0xffff0000, v86
    v_fmac_f32 v60, v44, v133
    v_fmac_f32 v61, v45, v133
    v_lshlrev_b32 v44, 16, v87
    v_and_b32 v45, 0xffff0000, v87
    v_fmac_f32 v62, v44, v133
    v_fmac_f32 v63, v45, v133
    v_lshlrev_b32 v44, 16, v88
    v_and_b32 v45, 0xffff0000, v88
    v_fmac_f32 v56, v44, v134
    v_fmac_f32 v57, v45, v134
    v_lshlrev_b32 v44, 16, v89
    v_and_b32 v45, 0xffff0000, v89
    v_fmac_f32 v58, v44, v134
    v_fmac_f32 v59, v45, v134
    v_lshlrev_b32 v44, 16, v90
    v_and_b32 v45, 0xffff0000, v90
    v_fmac_f32 v60, v44, v134
    v_fmac_f32 v61, v45, v134
    v_lshlrev_b32 v44, 16, v91
    v_and_b32 v45, 0xffff0000, v91
    v_fmac_f32 v62, v44, v134
    v_fmac_f32 v63, v45, v134
    v_lshlrev_b32 v44, 16, v92
    v_and_b32 v45, 0xffff0000, v92
    v_fmac_f32 v56, v44, v135
    v_fmac_f32 v57, v45, v135
    v_lshlrev_b32 v44, 16, v93
    v_and_b32 v45, 0xffff0000, v93
    v_fmac_f32 v58, v44, v135
    v_fmac_f32 v59, v45, v135
    v_lshlrev_b32 v44, 16, v94
    v_and_b32 v45, 0xffff0000, v94
    v_fmac_f32 v60, v44, v135
    v_fmac_f32 v61, v45, v135
    v_lshlrev_b32 v44, 16, v95
    v_and_b32 v45, 0xffff0000, v95
    v_fmac_f32 v62, v44, v135
    v_fmac_f32 v63, v45, v135
    s_sub_u32 s32, s32, 1
    s_cmp_lg_u32 s32, 0
    s_cbranch_scc1 L_f2
    v_lshlrev_b32 v44, 5, v0
    ds_write_b128 v44, v[56:59] offset:6144
    ds_write_b128 v44, v[60:63] offset:6160
    v_lshlrev_b32 v44, 3, v0
    s_waitcnt lgkmcnt(0)
    ds_read_b64 v[64:65], v44 offset:6144
    v_mov_b32 v66, v4
    v_mov_b32 v67, v5
    ds_read_b64 v[68:69], v44 offset:6656
    v_mov_b32 v70, v4
    v_mov_b32 v71, v5
    ds_read_b64 v[72:73], v44 offset:7168
    v_mov_b32 v74, v4
    v_mov_b32 v75, v5
    ds_read_b64 v[76:77], v44 offset:7680
    v_mov_b32 v78, v4
    v_mov_b32 v79, v5
    s_lshl_b32 s29, s35, 12
    s_add_u32 s29, s29, 1310720
    s_waitcnt lgkmcnt(0)
    buffer_store_dwordx4 v[64:67], v35, s[12:15], s29 offen offset:0 sc1
    buffer_store_dwordx4 v[68:71], v35, s[12:15], s29 offen offset:1024 sc1
    buffer_store_dwordx4 v[72:75], v35, s[12:15], s29 offen offset:2048 sc1
    buffer_store_dwordx4 v[76:79], v35, s[12:15], s29 offen offset:3072 sc1
L_noffn:
    s_cmp_lg_u32 s2, 0
    s_cbranch_scc1 L_noep
    v_lshlrev_b32 v45, 10, v0
    s_mov_b32 s34, 400000
L_pe:
    s_mov_b32 s33, 65536
    buffer_load_dwordx4 v[64:67], v45, s[12:15], s33 offen sc1
    s_mov_b32 s33, 131072
    buffer_load_dwordx4 v[68:71], v45, s[12:15], s33 offen sc1
    s_mov_b32 s33, 196608
    buffer_load_dwordx4 v[72:75], v45, s[12:15], s33 offen sc1
    s_mov_b32 s33, 262144
    buffer_load_dwordx4 v[76:79], v45, s[12:15], s33 offen sc1
    s_waitcnt vmcnt(0)
    s_mov_b64 s[30:31], -1
    v_cmp_eq_u64 vcc, v[66:67], v[4:5]
    s_and_b64 s[30:31], s[30:31], vcc
    v_cmp_eq_u64 vcc, v[70:71], v[4:5]
    s_and_b64 s[30:31], s[30:31], vcc
    v_cmp_eq_u64 vcc, v[74:75], v[4:5]
    s_and_b64 s[30:31], s[30:31], vcc
    v_cmp_eq_u64 vcc, v[78:79], v[4:5]
    s_and_b64 s[30:31], s[30:31], vcc
    s_cmp_eq_u64 s[30:31], -1
    s_cbranch_scc1 L_pe_ok
    s_sleep 8
    s_sub_u32 s34, s34, 1
    s_cmp_lg_u32 s34, 0
    s_cbranch_scc1 L_pe
L_pe_ok:
    s_mov_b64 exec, 1
    buffer_store_dwordx2 v[4:5], v36, s[12:15], 0 offen sc1
    s_mov_b64 exec, -1
L_noep:
    s_mov_b32 s29, 393216
    s_bfe_u32 s33, s21, 0x10000
    s_lshl_b32 s33, s33, 12
    s_add_u32 s29, s29, s33
    s_bfe_u32 s33, s21, 0x10001
    s_lshl_b32 s33, s33, 13
    s_add_u32 s29, s29, s33
    s_bfe_u32 s33, s21, 0x10002
    s_lshl_b32 s33, s33, 14
    s_add_u32 s29, s29, s33
    s_bfe_u32 s33, s21, 0x10003
    s_lshl_b32 s33, s33, 8
    s_add_u32 s29, s29, s33
    s_bfe_u32 s33, s21, 0x10004
    s_lshl_b32 s33, s33, 9
    s_add_u32 s29, s29, s33
    v_mov_b32 v44, s29
    v_mov_b32 v45, 0x7ffffff0
    v_cmp_eq_u32 vcc, 0, v0
    v_mov_b32 v46, 5888
    v_mov_b32 v47, 5120
    v_cndmask_b32 v44, v45, v44, vcc
    s_mov_b32 s36, 57
    s_mov_b32 s37, 0
    s_mov_b32 s60, s29
    s_and_b32 s69, s22, 3
    s_mov_b32 s61, s69
    s_bfe_u32 s62, s61, 0x10000
    s_lshl_b32 s62, s62, 10
    s_bfe_u32 s33, s61, 0x10001
    s_lshl_b32 s33, s33, 11
    s_add_u32 s62, s62, s33
    s_add_u32 s62, s62, s60
    s_mov_b32 s64, 0
    s_mov_b32 s65, 0
    s_mov_b32 s68, 0
    v_mov_b32 v48, 0
    v_cndmask_b32 v44, v45, v48, vcc
    v_and_b32 v49, 1, v0
    v_lshlrev_b32 v48, 10, v49
    v_bfe_u32 v49, v0, 1, 1
    v_lshl_add_u32 v48, v49, 11, v48
    v_cmp_gt_u32 vcc, 4, v0
    v_xor_b32 v50, s69, v0
    v_cndmask_b32 v48, v45, v48, vcc
    v_mov_b32 v51, 0
    v_mov_b32 v49, 0x7fffffff
L_tk:
    s_mov_b32 s34, 400000
L_tkw:
    ds_read_b128 v[64:67], v46
    s_waitcnt lgkmcnt(0)
    v_max3_u32 v64, v64, v65, v66
    v_max_u32 v64, v64, v67
    s_nop 0
    v_readfirstlane_b32 s29, v64
    s_cmp_ge_u32 s29, s36
    s_cbranch_scc1 L_tkw_go
    s_sleep 2
    s_sub_u32 s34, s34, 1
    s_cmp_lg_u32 s34, 0
    s_cbranch_scc1 L_tkw
L_tkw_go:
L_tkrq:
    v_mov_b32 v65, 1
    buffer_atomic_add v65, v44, s[12:15], s62 offen sc0 sc1
    s_cmp_eq_u32 s68, 0
    s_cbranch_scc1 L_tknosn
    buffer_load_dword v51, v48, s[12:15], s60 offen sc1
L_tknosn:
    s_waitcnt vmcnt(0)
    v_readfirstlane_b32 s29, v65
    s_cmp_lt_u32 s29, 10
    s_cbranch_scc1 L_tkok
    s_bitset1_b32 s64, s61
    s_mov_b32 s68, 1
    v_min_u32 v52, 10, v51
    v_lshl_or_b32 v52, v52, 2, v50
    v_cndmask_b32 v52, v52, v49, s[64:65]
    s_nop 1
    v_min_u32_dpp v52, v52, v52 quad_perm:[1,0,3,2] row_mask:0xf bank_mask:0xf
    s_nop 1
    v_min_u32_dpp v52, v52, v52 quad_perm:[2,3,0,1] row_mask:0xf bank_mask:0xf
    s_nop 1
    v_readfirstlane_b32 s30, v52
    s_and_b32 s61, s30, 3
    s_xor_b32 s61, s61, s69
    s_bfe_u32 s62, s61, 0x10000
    s_lshl_b32 s62, s62, 10
    s_bfe_u32 s33, s61, 0x10001
    s_lshl_b32 s33, s33, 11
    s_add_u32 s62, s62, s33
    s_add_u32 s62, s62, s60
    s_cmp_ge_u32 s30, 40
    s_cbranch_scc1 L_tkexh
    s_branch L_tkrq
L_tkok:
    s_lshr_b32 s33, s29, 1
    s_lshl_b32 s33, s33, 5
    s_and_b32 s30, s29, 1
    s_lshl_b32 s30, s30, 4
    s_add_u32 s33, s33, s30
    s_lshl_b32 s30, s61, 2
    s_add_u32 s33, s33, s30
    v_mov_b32 v65, s33
    ds_write_b32 v47, v65
    v_add_u32 v47, 4, v47
    s_add_u32 s36, s36, 1
    s_add_u32 s37, s37, 1
    s_cmp_ge_u32 s29, 6
    s_cselect_b32 s68, 1, s68
    s_cmp_lt_u32 s29, 9
    s_cbranch_scc1 L_tknl
    s_bitset1_b32 s64, s61
L_tknl:
    s_bitcmp1_b32 s64, s69
    s_cbranch_scc0 L_tkown
    v_min_u32 v52, 10, v51
    v_lshl_or_b32 v52, v52, 2, v50
    v_cndmask_b32 v52, v52, v49, s[64:65]
    s_nop 1
    v_min_u32_dpp v52, v52, v52 quad_perm:[1,0,3,2] row_mask:0xf bank_mask:0xf
    s_nop 1
    v_min_u32_dpp v52, v52, v52 quad_perm:[2,3,0,1] row_mask:0xf bank_mask:0xf
    s_nop 1
    v_readfirstlane_b32 s30, v52
    s_and_b32 s61, s30, 3
    s_xor_b32 s61, s61, s69
    s_bfe_u32 s62, s61, 0x10000
    s_lshl_b32 s62, s62, 10
    s_bfe_u32 s33, s61, 0x10001
    s_lshl_b32 s33, s33, 11
    s_add_u32 s62, s62, s33
    s_add_u32 s62, s62, s60
    s_cmp_ge_u32 s30, 40
    s_cbranch_scc1 L_tkexh
L_tkown:
    s_cmp_lt_u32 s37, 180
    s_cbranch_scc1 L_tk
L_tkexh:
    v_mov_b32 v65, 160
    ds_write_b32 v47, v65
    v_add_u32 v47, 4, v47
    s_lshl_b32 s66, s22, 2
    s_add_u32 s66, s66, s21
    s_cmp_ge_u32 s21, 4
    s_cbranch_scc1 L_nocons1
    v_lshrrev_b32 v45, 3, v0
    v_lshlrev_b32 v45, 12, v45
    v_and_b32 v46, 7, v0
    v_lshl_add_u32 v45, v46, 4, v45
    s_lshl_b32 s29, s66, 7
    s_add_u32 s29, s29, 1310720
    v_mov_b32 v47, 0x7ffffff0
    v_cmp_gt_u32 vcc, 24, v0
    s_nop 1
    v_cndmask_b32 v47, v47, v45, vcc
    s_mov_b32 s52, 0xff000000
    s_mov_b32 s53, -1
    s_mov_b32 s34, 400000
L_pf:
    s_add_u32 s33, s29, 0
    buffer_load_dwordx4 v[64:67], v45, s[12:15], s33 offen sc1
    s_add_u32 s33, s29, 32768
    buffer_load_dwordx4 v[68:71], v45, s[12:15], s33 offen sc1
    s_add_u32 s33, s29, 65536
    buffer_load_dwordx4 v[72:75], v45, s[12:15], s33 offen sc1
    s_add_u32 s33, s29, 98304
    buffer_load_dwordx4 v[76:79], v45, s[12:15], s33 offen sc1
    s_add_u32 s33, s29, 131072
    buffer_load_dwordx4 v[80:83], v45, s[12:15], s33 offen sc1
    s_add_u32 s33, s29, 163840
    buffer_load_dwordx4 v[84:87], v47, s[12:15], s33 offen sc1
    s_waitcnt vmcnt(0)
    s_mov_b64 s[30:31], -1
    v_cmp_eq_u64 vcc, v[66:67], v[4:5]
    s_and_b64 s[30:31], s[30:31], vcc
    v_cmp_eq_u64 vcc, v[70:71], v[4:5]
    s_and_b64 s[30:31], s[30:31], vcc
    v_cmp_eq_u64 vcc, v[74:75], v[4:5]
    s_and_b64 s[30:31], s[30:31], vcc
    v_cmp_eq_u64 vcc, v[78:79], v[4:5]
    s_and_b64 s[30:31], s[30:31], vcc
    v_cmp_eq_u64 vcc, v[82:83], v[4:5]
    s_and_b64 s[30:31], s[30:31], vcc
    v_cmp_eq_u64 vcc, v[86:87], v[4:5]
    s_or_b64 vcc, vcc, s[52:53]
    s_and_b64 s[30:31], s[30:31], vcc
    s_cmp_eq_u64 s[30:31], -1
    s_cbranch_scc1 L_pf_ok
    s_sleep 8
    s_sub_u32 s34, s34, 1
    s_cmp_lg_u32 s34, 0
    s_cbranch_scc1 L_pf
L_pf_ok:
    v_add_f32 v56, v64, v68
    v_add_f32 v57, v65, v69
    v_add_f32 v56, v56, v72
    v_add_f32 v57, v57, v73
    v_add_f32 v56, v56, v76
    v_add_f32 v57, v57, v77
    v_add_f32 v56, v56, v80
    v_add_f32 v57, v57, v81
    v_add_f32 v56, v56, v84
    v_add_f32 v57, v57, v85
    s_nop 1
    v_add_f32_dpp v56, v56, v56 row_ror:8 row_mask:0xf bank_mask:0xf
    v_mov_b32 v44, v56
    s_nop 1
    v_permlane16_swap_b32 v56, v44
    v_add_f32 v56, v56, v44
    v_mov_b32 v44, v56
    s_nop 1
    v_permlane32_swap_b32 v56, v44
    v_add_f32 v56, v56, v44
    s_nop 1
    v_add_f32_dpp v57, v57, v57 row_ror:8 row_mask:0xf bank_mask:0xf
    v_mov_b32 v44, v57
    s_nop 1
    v_permlane16_swap_b32 v57, v44
    v_add_f32 v57, v57, v44
    v_mov_b32 v44, v57
    s_nop 1
    v_permlane32_swap_b32 v57, v44
    v_add_f32 v57, v57, v44
    v_cvt_pk_bf16_f32 v56, v56, v56
    v_and_b32 v56, 0xffff0000, v56
    v_mul_f32 v44, 0xbfb8aa3b, v56
    v_exp_f32 v44, v44
    s_nop 0
    v_add_f32 v44, 1.0, v44
    v_rcp_f32 v44, v44
    s_nop 0
    v_mul_f32 v56, v56, v44
    v_cvt_pk_bf16_f32 v56, v56, v56
    v_and_b32 v56, 0xffff0000, v56
    v_cvt_pk_bf16_f32 v57, v57, v57
    v_and_b32 v57, 0xffff0000, v57
    v_mul_f32 v44, 0xbfb8aa3b, v57
    v_exp_f32 v44, v44
    s_nop 0
    v_add_f32 v44, 1.0, v44
    v_rcp_f32 v44, v44
    s_nop 0
    v_mul_f32 v57, v57, v44
    v_cvt_pk_bf16_f32 v57, v57, v57
    v_and_b32 v57, 0xffff0000, v57
    s_mov_b32 s8, s4
    s_mov_b32 s9, s5
    s_mov_b32 s10, 1024
    s_mov_b32 s11, 0x20000
    s_lshl_b32 s29, s66, 5
    v_lshlrev_b32 v46, 2, v46
    buffer_load_dword v58, v46, s[8:11], s29 offen
    s_waitcnt vmcnt(0)
    v_and_b32 v59, 0xffff0000, v58
    v_lshlrev_b32 v58, 16, v58
    v_lshlrev_b32 v44, 2, v46
    ds_write_b128 v44, v[56:59] offset:4864
    v_mov_b32 v44, 0
    ds_write_b64 v44, v[4:5] offset:4992
L_nocons1:
    v_mov_b32 v44, 0
    v_lshlrev_b32 v45, 3, v0
    v_cmp_eq_u32 s[52:53], 1, v33
    v_cmp_eq_u32 s[54:55], 2, v33
    v_cmp_eq_u32 s[56:57], 3, v33
    v_lshlrev_b32 v46, 4, v33
    v_lshlrev_b32 v47, 2, v0
    s_mov_b32 s30, 0x3e0293ee
    s_mov_b32 s31, 0xbe0293ee
    s_lshl_b32 s29, s2, 10
    s_add_u32 s29, s29, 524288
    s_lshl_b32 s32, s21, 13
    s_add_u32 s32, s32, 524288
    s_lshl_b32 s35, 1, s22
    s_xor_b32 s35, s35, 0xff
    s_add_u32 s40, s22, 1
    s_and_b32 s40, s40, 7
    s_lshl_b32 s40, s40, 10
    s_add_u32 s40, s40, s32
    s_add_u32 s41, s22, 2
    s_and_b32 s41, s41, 7
    s_lshl_b32 s41, s41, 10
    s_add_u32 s41, s41, s32
    s_add_u32 s42, s22, 3
    s_and_b32 s42, s42, 7
    s_lshl_b32 s42, s42, 10
    s_add_u32 s42, s42, s32
    s_add_u32 s43, s22, 4
    s_and_b32 s43, s43, 7
    s_lshl_b32 s43, s43, 10
    s_add_u32 s43, s43, s32
    s_add_u32 s44, s22, 5
    s_and_b32 s44, s44, 7
    s_lshl_b32 s44, s44, 10
    s_add_u32 s44, s44, s32
    s_add_u32 s45, s22, 6
    s_and_b32 s45, s45, 7
    s_lshl_b32 s45, s45, 10
    s_add_u32 s45, s45, s32
    s_add_u32 s46, s22, 7
    s_and_b32 s46, s46, 7
    s_lshl_b32 s46, s46, 10
    s_add_u32 s46, s46, s32
    s_waitcnt vmcnt(0)
    s_waitcnt lgkmcnt(0)
    s_barrier
    s_setprio 3
    ds_read_b32 v80, v44 offset:4368
    ds_read_b32 v81, v44 offset:4400
    ds_read_b32 v82, v44 offset:4432
    ds_read_b32 v83, v44 offset:4464
    ds_read_b128 v[64:67], v44 offset:4352
    ds_read_b128 v[68:71], v44 offset:4384
    ds_read_b128 v[72:75], v44 offset:4416
    ds_read_b128 v[76:79], v44 offset:4448
    ds_read_b64 v[84:85], v45 offset:2304
    ds_read_b64 v[86:87], v45 offset:2816
    ds_read_b64 v[88:89], v45 offset:3328
    ds_read_b64 v[90:91], v45 offset:3840
    buffer_load_dwordx4 v[104:107], v35, s[12:15], s40 offen sc1
    buffer_load_dwordx4 v[108:111], v35, s[12:15], s41 offen sc1
    buffer_load_dwordx4 v[112:115], v35, s[12:15], s42 offen sc1
    buffer_load_dwordx4 v[116:119], v35, s[12:15], s43 offen sc1
    buffer_load_dwordx4 v[120:123], v35, s[12:15], s44 offen sc1
    buffer_load_dwordx4 v[124:127], v35, s[12:15], s45 offen sc1
    buffer_load_dwordx4 v[128:131], v35, s[12:15], s46 offen sc1
    s_waitcnt lgkmcnt(8)
    v_max3_f32 v92, v80, v81, v82
    v_max_f32 v92, v92, v83
    v_mul_f32 v93, s31, v92
    v_fma_f32 v80, v80, s30, v93
    v_fma_f32 v81, v81, s30, v93
    v_fma_f32 v82, v82, s30, v93
    v_fma_f32 v83, v83, s30, v93
    v_exp_f32 v80, v80
    v_exp_f32 v81, v81
    v_exp_f32 v82, v82
    v_exp_f32 v83, v83
    s_waitcnt lgkmcnt(4)
    v_add_f32 v64, v64, v65
    v_add_f32 v66, v66, v67
    v_add_f32 v68, v68, v69
    v_add_f32 v70, v70, v71
    v_add_f32 v72, v72, v73
    v_add_f32 v74, v74, v75
    v_add_f32 v76, v76, v77
    v_add_f32 v78, v78, v79
    v_add_f32 v64, v64, v66
    v_add_f32 v68, v68, v70
    v_add_f32 v72, v72, v74
    v_add_f32 v76, v76, v78
    v_mul_f32 v94, v64, v80
    v_fmac_f32 v94, v68, v81
    v_fmac_f32 v94, v72, v82
    v_fmac_f32 v94, v76, v83
    s_waitcnt lgkmcnt(0)
    v_rcp_f32 v95, v94
    v_log_f32 v96, v94
    v_mul_f32 v98, v84, v80
    v_mul_f32 v99, v85, v80
    v_fmac_f32 v98, v86, v81
    v_fmac_f32 v99, v87, v81
    v_fmac_f32 v98, v88, v82
    v_fmac_f32 v99, v89, v82
    v_fmac_f32 v98, v90, v83
    v_fmac_f32 v99, v91, v83
    v_sub_f32 v96, v96, v93
    v_mul_f32 v98, v98, v95
    v_mul_f32 v99, v99, v95
    v_mov_b32 v51, v4
    v_mov_b32 v50, v96
    v_mov_b32 v48, v98
    v_mov_b32 v49, v99
    buffer_store_dwordx4 v[48:51], v35, s[12:15], s29 offen sc1
    v_mov_b32 v97, 1.0
    s_waitcnt vmcnt(1)
    v_cmp_ne_u32 s[90:91], v107, v4
    v_cmp_ne_u32 s[92:93], v111, v4
    v_cmp_ne_u32 s[94:95], v115, v4
    v_cmp_ne_u32 s[96:97], v119, v4
    v_cmp_ne_u32 s[98:99], v123, v4
    v_cmp_ne_u32 s[100:101], v127, v4
    v_cmp_ne_u32 s[40:41], v131, v4
    s_or_b64 s[60:61], s[90:91], s[92:93]
    s_or_b64 s[62:63], s[94:95], s[96:97]
    s_or_b64 s[60:61], s[60:61], s[62:63]
    s_or_b64 s[62:63], s[98:99], s[100:101]
    s_or_b64 s[60:61], s[60:61], s[62:63]
    s_or_b64 s[60:61], s[60:61], s[40:41]
    s_cbranch_scc1 L_e1_slow
    v_max3_f32 v100, v96, v106, v110
    v_max3_f32 v101, v114, v118, v122
    v_max3_f32 v100, v100, v126, v130
    v_max_f32 v100, v100, v101
    v_sub_f32 v96, v96, v100
    v_sub_f32 v106, v106, v100
    v_sub_f32 v110, v110, v100
    v_sub_f32 v114, v114, v100
    v_sub_f32 v118, v118, v100
    v_sub_f32 v122, v122, v100
    v_sub_f32 v126, v126, v100
    v_sub_f32 v130, v130, v100
    v_exp_f32 v96, v96
    v_exp_f32 v106, v106
    v_exp_f32 v110, v110
    v_exp_f32 v114, v114
    v_exp_f32 v118, v118
    v_exp_f32 v122, v122
    v_exp_f32 v126, v126
    v_exp_f32 v130, v130
    v_mul_f32 v98, v98, v96
    v_mul_f32 v99, v99, v96
    v_add_f32 v97, v96, v106
    v_add_f32 v101, v110, v114
    v_add_f32 v102, v118, v122
    v_add_f32 v103, v126, v130
    v_fmac_f32 v98, v104, v106
    v_fmac_f32 v99, v105, v106
    v_fmac_f32 v98, v108, v110
    v_fmac_f32 v99, v109, v110
    v_fmac_f32 v98, v112, v114
    v_fmac_f32 v99, v113, v114
    v_fmac_f32 v98, v116, v118
    v_fmac_f32 v99, v117, v118
    v_fmac_f32 v98, v120, v122
    v_fmac_f32 v99, v121, v122
    v_fmac_f32 v98, v124, v126
    v_fmac_f32 v99, v125, v126
    v_fmac_f32 v98, v128, v130
    v_fmac_f32 v99, v129, v130
    v_add_f32 v97, v97, v101
    v_add_f32 v102, v102, v103
    v_add_f32 v97, v97, v102
    s_branch L_e1_done
L_e1_slow:
    s_mov_b32 s63, 0
    s_cmp_lg_u64 s[40:41], 0
    s_addc_u32 s63, s63, s63
    s_cmp_lg_u64 s[100:101], 0
    s_addc_u32 s63, s63, s63
    s_cmp_lg_u64 s[98:99], 0
    s_addc_u32 s63, s63, s63
    s_cmp_lg_u64 s[96:97], 0
    s_addc_u32 s63, s63, s63
    s_cmp_lg_u64 s[94:95], 0
    s_addc_u32 s63, s63, s63
    s_cmp_lg_u64 s[92:93], 0
    s_addc_u32 s63, s63, s63
    s_cmp_lg_u64 s[90:91], 0
    s_addc_u32 s63, s63, s63
    s_add_u32 s62, s22, 1
    s_lshl_b32 s63, s63, s62
    s_lshr_b32 s62, s63, 8
    s_or_b32 s63, s63, s62
    s_and_b32 s35, s63, 0xff
    s_mov_b32 s60, s35
    s_mov_b32 s61, 0
    s_mov_b32 s34, 400000
    s_lshl_b32 s62, -1, s61
    s_and_b32 s62, s62, s60
    s_cselect_b32 s62, s62, s60
    s_ff1_i32_b32 s86, s62
    s_add_u32 s61, s86, 1
    s_lshl_b32 s63, s86, 10
    s_add_u32 s63, s63, s32
    buffer_load_dwordx4 v[64:67], v35, s[12:15], s63 offen sc1
    s_lshl_b32 s62, -1, s61
    s_and_b32 s62, s62, s60
    s_cselect_b32 s62, s62, s60
    s_ff1_i32_b32 s87, s62
    s_add_u32 s61, s87, 1
    s_lshl_b32 s63, s87, 10
    s_add_u32 s63, s63, s32
    buffer_load_dwordx4 v[68:71], v35, s[12:15], s63 offen sc1
    s_lshl_b32 s62, -1, s61
    s_and_b32 s62, s62, s60
    s_cselect_b32 s62, s62, s60
    s_ff1_i32_b32 s88, s62
    s_add_u32 s61, s88, 1
    s_lshl_b32 s63, s88, 10
    s_add_u32 s63, s63, s32
    buffer_load_dwordx4 v[72:75], v35, s[12:15], s63 offen sc1
    s_lshl_b32 s62, -1, s61
    s_and_b32 s62, s62, s60
    s_cselect_b32 s62, s62, s60
    s_ff1_i32_b32 s89, s62
    s_add_u32 s61, s89, 1
    s_lshl_b32 s63, s89, 10
    s_add_u32 s63, s63, s32
    buffer_load_dwordx4 v[76:79], v35, s[12:15], s63 offen sc1
    v_mov_b32 v103, 0xff800000
    s_cmp_lg_u64 s[90:91], 0
    s_cselect_b64 s[90:91], -1, 0
    s_cmp_lg_u64 s[92:93], 0
    s_cselect_b64 s[92:93], -1, 0
    s_cmp_lg_u64 s[94:95], 0
    s_cselect_b64 s[94:95], -1, 0
    s_cmp_lg_u64 s[96:97], 0
    s_cselect_b64 s[96:97], -1, 0
    s_cmp_lg_u64 s[98:99], 0
    s_cselect_b64 s[98:99], -1, 0
    s_cmp_lg_u64 s[100:101], 0
    s_cselect_b64 s[100:101], -1, 0
    s_cmp_lg_u64 s[40:41], 0
    s_cselect_b64 s[40:41], -1, 0
    v_cndmask_b32 v106, v106, v103, s[90:91]
    v_cndmask_b32 v104, v104, 0, s[90:91]
    v_cndmask_b32 v105, v105, 0, s[90:91]
    v_cndmask_b32 v110, v110, v103, s[92:93]
    v_cndmask_b32 v108, v108, 0, s[92:93]
    v_cndmask_b32 v109, v109, 0, s[92:93]
    v_cndmask_b32 v114, v114, v103, s[94:95]
    v_cndmask_b32 v112, v112, 0, s[94:95]
    v_cndmask_b32 v113, v113, 0, s[94:95]
    v_cndmask_b32 v118, v118, v103, s[96:97]
    v_cndmask_b32 v116, v116, 0, s[96:97]
    v_cndmask_b32 v117, v117, 0, s[96:97]
    v_cndmask_b32 v122, v122, v103, s[98:99]
    v_cndmask_b32 v120, v120, 0, s[98:99]
    v_cndmask_b32 v121, v121, 0, s[98:99]
    v_cndmask_b32 v126, v126, v103, s[100:101]
    v_cndmask_b32 v124, v124, 0, s[100:101]
    v_cndmask_b32 v125, v125, 0, s[100:101]
    v_cndmask_b32 v130, v130, v103, s[40:41]
    v_cndmask_b32 v128, v128, 0, s[40:41]
    v_cndmask_b32 v129, v129, 0, s[40:41]
    v_max3_f32 v100, v96, v106, v110
    v_max3_f32 v101, v114, v118, v122
    v_max3_f32 v100, v100, v126, v130
    v_max_f32 v100, v100, v101
    v_sub_f32 v96, v96, v100
    v_sub_f32 v106, v106, v100
    v_sub_f32 v110, v110, v100
    v_sub_f32 v114, v114, v100
    v_sub_f32 v118, v118, v100
    v_sub_f32 v122, v122, v100
    v_sub_f32 v126, v126, v100
    v_sub_f32 v130, v130, v100
    v_exp_f32 v96, v96
    v_exp_f32 v106, v106
    v_exp_f32 v110, v110
    v_exp_f32 v114, v114
    v_exp_f32 v118, v118
    v_exp_f32 v122, v122
    v_exp_f32 v126, v126
    v_exp_f32 v130, v130
    v_mul_f32 v98, v98, v96
    v_mul_f32 v99, v99, v96
    v_add_f32 v97, v96, v106
    v_add_f32 v101, v110, v114
    v_add_f32 v102, v118, v122
    v_add_f32 v103, v126, v130
    v_fmac_f32 v98, v104, v106
    v_fmac_f32 v99, v105, v106
    v_fmac_f32 v98, v108, v110
    v_fmac_f32 v99, v109, v110
    v_fmac_f32 v98, v112, v114
    v_fmac_f32 v99, v113, v114
    v_fmac_f32 v98, v116, v118
    v_fmac_f32 v99, v117, v118
    v_fmac_f32 v98, v120, v122
    v_fmac_f32 v99, v121, v122
    v_fmac_f32 v98, v124, v126
    v_fmac_f32 v99, v125, v126
    v_fmac_f32 v98, v128, v130
    v_fmac_f32 v99, v129, v130
    v_add_f32 v97, v97, v101
    v_add_f32 v102, v102, v103
    v_add_f32 v97, v97, v102
    v_mov_b32 v96, v100
L_e1:
    s_waitcnt vmcnt(3)
    v_cmp_eq_u32 vcc, v67, v4
    s_lshl_b32 s62, 1, s86
    s_cmp_eq_u64 vcc, -1
    s_cselect_b32 s62, s62, 0
    s_and_b32 s62, s62, s60
    s_cbranch_scc0 L_e1_s0
    s_xor_b32 s60, s60, s62
    v_max_f32 v100, v96, v66
    v_sub_f32 v101, v96, v100
    v_sub_f32 v102, v66, v100
    v_exp_f32 v101, v101
    v_exp_f32 v102, v102
    v_mov_b32 v96, v100
    v_mul_f32 v98, v98, v101
    v_mul_f32 v99, v99, v101
    v_fma_f32 v97, v97, v101, v102
    v_fmac_f32 v98, v64, v102
    v_fmac_f32 v99, v65, v102
    s_cmp_eq_u32 s60, 0
    s_cbranch_scc1 L_e1_ok
L_e1_s0:
    s_lshl_b32 s62, -1, s61
    s_and_b32 s62, s62, s60
    s_cselect_b32 s62, s62, s60
    s_ff1_i32_b32 s86, s62
    s_add_u32 s61, s86, 1
    s_lshl_b32 s63, s86, 10
    s_add_u32 s63, s63, s32
    buffer_load_dwordx4 v[64:67], v35, s[12:15], s63 offen sc1
    s_waitcnt vmcnt(3)
    v_cmp_eq_u32 vcc, v71, v4
    s_lshl_b32 s62, 1, s87
    s_cmp_eq_u64 vcc, -1
    s_cselect_b32 s62, s62, 0
    s_and_b32 s62, s62, s60
    s_cbranch_scc0 L_e1_s1
    s_xor_b32 s60, s60, s62
    v_max_f32 v100, v96, v70
    v_sub_f32 v101, v96, v100
    v_sub_f32 v102, v70, v100
    v_exp_f32 v101, v101
    v_exp_f32 v102, v102
    v_mov_b32 v96, v100
    v_mul_f32 v98, v98, v101
    v_mul_f32 v99, v99, v101
    v_fma_f32 v97, v97, v101, v102
    v_fmac_f32 v98, v68, v102
    v_fmac_f32 v99, v69, v102
    s_cmp_eq_u32 s60, 0
    s_cbranch_scc1 L_e1_ok
L_e1_s1:
    s_lshl_b32 s62, -1, s61
    s_and_b32 s62, s62, s60
    s_cselect_b32 s62, s62, s60
    s_ff1_i32_b32 s87, s62
    s_add_u32 s61, s87, 1
    s_lshl_b32 s63, s87, 10
    s_add_u32 s63, s63, s32
    buffer_load_dwordx4 v[68:71], v35, s[12:15], s63 offen sc1
    s_waitcnt vmcnt(3)
    v_cmp_eq_u32 vcc, v75, v4
    s_lshl_b32 s62, 1, s88
    s_cmp_eq_u64 vcc, -1
    s_cselect_b32 s62, s62, 0
    s_and_b32 s62, s62, s60
    s_cbranch_scc0 L_e1_s2
    s_xor_b32 s60, s60, s62
    v_max_f32 v100, v96, v74
    v_sub_f32 v101, v96, v100
    v_sub_f32 v102, v74, v100
    v_exp_f32 v101, v101
    v_exp_f32 v102, v102
    v_mov_b32 v96, v100
    v_mul_f32 v98, v98, v101
    v_mul_f32 v99, v99, v101
    v_fma_f32 v97, v97, v101, v102
    v_fmac_f32 v98, v72, v102
    v_fmac_f32 v99, v73, v102
    s_cmp_eq_u32 s60, 0
    s_cbranch_scc1 L_e1_ok
L_e1_s2:
    s_lshl_b32 s62, -1, s61
    s_and_b32 s62, s62, s60
    s_cselect_b32 s62, s62, s60
    s_ff1_i32_b32 s88, s62
    s_add_u32 s61, s88, 1
    s_lshl_b32 s63, s88, 10
    s_add_u32 s63, s63, s32
    buffer_load_dwordx4 v[72:75], v35, s[12:15], s63 offen sc1
    s_waitcnt vmcnt(3)
    v_cmp_eq_u32 vcc, v79, v4
    s_lshl_b32 s62, 1, s89
    s_cmp_eq_u64 vcc, -1
    s_cselect_b32 s62, s62, 0
    s_and_b32 s62, s62, s60
    s_cbranch_scc0 L_e1_s3
    s_xor_b32 s60, s60, s62
    v_max_f32 v100, v96, v78
    v_sub_f32 v101, v96, v100
    v_sub_f32 v102, v78, v100
    v_exp_f32 v101, v101
    v_exp_f32 v102, v102
    v_mov_b32 v96, v100
    v_mul_f32 v98, v98, v101
    v_mul_f32 v99, v99, v101
    v_fma_f32 v97, v97, v101, v102
    v_fmac_f32 v98, v76, v102
    v_fmac_f32 v99, v77, v102
    s_cmp_eq_u32 s60, 0
    s_cbranch_scc1 L_e1_ok
L_e1_s3:
    s_lshl_b32 s62, -1, s61
    s_and_b32 s62, s62, s60
    s_cselect_b32 s62, s62, s60
    s_ff1_i32_b32 s89, s62
    s_add_u32 s61, s89, 1
    s_lshl_b32 s63, s89, 10
    s_add_u32 s63, s63, s32
    buffer_load_dwordx4 v[76:79], v35, s[12:15], s63 offen sc1
    s_sub_u32 s34, s34, 1
    s_cmp_lg_u32 s34, 0
    s_cbranch_scc1 L_e1
L_e1_ok:
L_e1_done:
    v_rcp_f32 v97, v97
    s_nop 0
    v_mul_f32 v98, v98, v97
    v_mul_f32 v99, v99, v97
    v_cvt_pk_bf16_f32 v98, v98, v99
    ds_write_b32 v47, v98 offset:4608
    s_lshl_b32 s29, s21, 12
    s_lshl_b32 s30, s22, 9
    s_add_u32 s29, s29, s30
    s_add_u32 s29, s29, 1048576
    v_lshlrev_b32 v45, 3, v0
    s_waitcnt lgkmcnt(0)
    ds_read_b128 v[104:107], v46 offset:4608
    ds_read_b128 v[108:111], v46 offset:4672
    ds_read_b128 v[112:115], v46 offset:4736
    ds_read_b128 v[116:119], v46 offset:4800
    s_waitcnt lgkmcnt(3)
    v_mfma_f32_16x16x32_bf16 v[128:131], v[104:107], v[160:163], 0
    v_mfma_f32_16x16x32_bf16 v[132:135], v[104:107], v[176:179], 0
    v_mfma_f32_16x16x32_bf16 v[136:139], v[104:107], v[192:195], 0
    v_mfma_f32_16x16x32_bf16 v[140:143], v[104:107], v[208:211], 0
    s_waitcnt lgkmcnt(2)
    v_mfma_f32_16x16x32_bf16 v[128:131], v[108:111], v[164:167], v[128:131]
    v_mfma_f32_16x16x32_bf16 v[132:135], v[108:111], v[180:183], v[132:135]
    v_mfma_f32_16x16x32_bf16 v[136:139], v[108:111], v[196:199], v[136:139]
    v_mfma_f32_16x16x32_bf16 v[140:143], v[108:111], v[212:215], v[140:143]
    s_waitcnt lgkmcnt(1)
    v_mfma_f32_16x16x32_bf16 v[128:131], v[112:115], v[168:171], v[128:131]
    v_mfma_f32_16x16x32_bf16 v[132:135], v[112:115], v[184:187], v[132:135]
    v_mfma_f32_16x16x32_bf16 v[136:139], v[112:115], v[200:203], v[136:139]
    v_mfma_f32_16x16x32_bf16 v[140:143], v[112:115], v[216:219], v[140:143]
    s_waitcnt lgkmcnt(0)
    v_mfma_f32_16x16x32_bf16 v[128:131], v[116:119], v[172:175], v[128:131]
    v_mfma_f32_16x16x32_bf16 v[132:135], v[116:119], v[188:191], v[132:135]
    v_mfma_f32_16x16x32_bf16 v[136:139], v[116:119], v[204:207], v[136:139]
    v_mfma_f32_16x16x32_bf16 v[140:143], v[116:119], v[220:223], v[140:143]
    v_mov_b32 v50, v4
    v_mov_b32 v51, v5
    s_nop 5
    v_cndmask_b32 v48, v128, v132, s[52:53]
    v_cndmask_b32 v48, v48, v136, s[54:55]
    v_cndmask_b32 v48, v48, v140, s[56:57]
    s_nop 1
    v_mov_b32_dpp v49, v48 quad_perm:[1,0,3,2] row_mask:0xf bank_mask:0xf
    s_mov_b32 exec_lo, 0x55555555
    s_mov_b32 exec_hi, 0x55555555
    s_add_u32 s30, s29, 131072
    buffer_store_dwordx4 v[48:51], v45, s[12:15], s30 offen
    buffer_store_dwordx4 v[48:51], v45, s[12:15], s29 offen sc1
    s_mov_b64 exec, -1
    s_branch L_hend
L_scons:
    s_setprio 3
    s_load_dwordx2 s[50:51], s[0:1], 72
    s_mov_b32 s12, s24
    s_mov_b32 s13, s25
    s_mov_b32 s14, 0x200000
    s_mov_b32 s15, 0x20000
    v_mov_b32 v44, 0
    ds_read_b64 v[4:5], v44 offset:4992
    v_and_b32 v46, 7, v0
    v_lshlrev_b32 v47, 4, v46
    ds_read_b128 v[56:59], v47 offset:4864
    s_lshl_b32 s66, s22, 2
    s_add_u32 s66, s66, s21
    s_waitcnt lgkmcnt(0)
    v_lshrrev_b32 v45, 3, v0
    v_lshlrev_b32 v45, 12, v45
    v_and_b32 v46, 7, v0
    v_lshl_add_u32 v45, v46, 4, v45
    s_lshl_b32 s32, s66, 7
    s_add_u32 s32, s32, 1048576
    s_mov_b32 s65, s32
    s_add_u32 s64, s32, 131072
    s_mov_b32 s32, s64
    v_mov_b32 v52, 0
    v_mov_b32 v53, 0
    s_mov_b32 s60, 15
    s_mov_b32 s61, 0
    s_mov_b32 s34, 400000
    s_lshl_b32 s62, -1, s61
    s_and_b32 s62, s62, s60
    s_cselect_b32 s62, s62, s60
    s_ff1_i32_b32 s86, s62
    s_add_u32 s61, s86, 1
    s_lshl_b32 s63, s86, 15
    s_add_u32 s63, s63, s32
    buffer_load_dwordx4 v[224:227], v45, s[12:15], s63 offen sc1
    s_lshl_b32 s62, -1, s61
    s_and_b32 s62, s62, s60
    s_cselect_b32 s62, s62, s60
    s_ff1_i32_b32 s87, s62
    s_add_u32 s61, s87, 1
    s_lshl_b32 s63, s87, 15
    s_add_u32 s63, s63, s32
    buffer_load_dwordx4 v[228:231], v45, s[12:15], s63 offen sc1
    s_lshl_b32 s62, -1, s61
    s_and_b32 s62, s62, s60
    s_cselect_b32 s62, s62, s60
    s_ff1_i32_b32 s88, s62
    s_add_u32 s61, s88, 1
    s_lshl_b32 s63, s88, 15
    s_add_u32 s63, s63, s32
    buffer_load_dwordx4 v[232:235], v45, s[12:15], s63 offen sc1
    s_lshl_b32 s62, -1, s61
    s_and_b32 s62, s62, s60
    s_cselect_b32 s62, s62, s60
    s_ff1_i32_b32 s89, s62
    s_add_u32 s61, s89, 1
    s_lshl_b32 s63, s89, 15
    s_add_u32 s63, s63, s32
    buffer_load_dwordx4 v[236:239], v45, s[12:15], s63 offen sc1
L_e2:
    s_waitcnt vmcnt(3)
    v_cmp_eq_u64 vcc, v[226:227], v[4:5]
    s_lshl_b32 s62, 1, s86
    s_cmp_eq_u64 vcc, -1
    s_cselect_b32 s62, s62, 0
    s_and_b32 s62, s62, s60
    s_cbranch_scc0 L_e2_s0
    s_xor_b32 s60, s60, s62
    v_add_f32 v52, v52, v224
    v_add_f32 v53, v53, v225
    s_cmp_eq_u32 s60, 0
    s_cbranch_scc1 L_e2_ok
L_e2_s0:
    s_lshl_b32 s62, -1, s61
    s_and_b32 s62, s62, s60
    s_cselect_b32 s62, s62, s60
    s_ff1_i32_b32 s86, s62
    s_add_u32 s61, s86, 1
    s_lshl_b32 s63, s86, 15
    s_add_u32 s63, s63, s32
    buffer_load_dwordx4 v[224:227], v45, s[12:15], s63 offen sc1
    s_waitcnt vmcnt(3)
    v_cmp_eq_u64 vcc, v[230:231], v[4:5]
    s_lshl_b32 s62, 1, s87
    s_cmp_eq_u64 vcc, -1
    s_cselect_b32 s62, s62, 0
    s_and_b32 s62, s62, s60
    s_cbranch_scc0 L_e2_s1
    s_xor_b32 s60, s60, s62
    v_add_f32 v52, v52, v228
    v_add_f32 v53, v53, v229
    s_cmp_eq_u32 s60, 0
    s_cbranch_scc1 L_e2_ok
L_e2_s1:
    s_lshl_b32 s62, -1, s61
    s_and_b32 s62, s62, s60
    s_cselect_b32 s62, s62, s60
    s_ff1_i32_b32 s87, s62
    s_add_u32 s61, s87, 1
    s_lshl_b32 s63, s87, 15
    s_add_u32 s63, s63, s32
    buffer_load_dwordx4 v[228:231], v45, s[12:15], s63 offen sc1
    s_waitcnt vmcnt(3)
    v_cmp_eq_u64 vcc, v[234:235], v[4:5]
    s_lshl_b32 s62, 1, s88
    s_cmp_eq_u64 vcc, -1
    s_cselect_b32 s62, s62, 0
    s_and_b32 s62, s62, s60
    s_cbranch_scc0 L_e2_s2
    s_xor_b32 s60, s60, s62
    v_add_f32 v52, v52, v232
    v_add_f32 v53, v53, v233
    s_cmp_eq_u32 s60, 0
    s_cbranch_scc1 L_e2_ok
L_e2_s2:
    s_lshl_b32 s62, -1, s61
    s_and_b32 s62, s62, s60
    s_cselect_b32 s62, s62, s60
    s_ff1_i32_b32 s88, s62
    s_add_u32 s61, s88, 1
    s_lshl_b32 s63, s88, 15
    s_add_u32 s63, s63, s32
    buffer_load_dwordx4 v[232:235], v45, s[12:15], s63 offen sc1
    s_waitcnt vmcnt(3)
    v_cmp_eq_u64 vcc, v[238:239], v[4:5]
    s_lshl_b32 s62, 1, s89
    s_cmp_eq_u64 vcc, -1
    s_cselect_b32 s62, s62, 0
    s_and_b32 s62, s62, s60
    s_cbranch_scc0 L_e2_s3
    s_xor_b32 s60, s60, s62
    v_add_f32 v52, v52, v236
    v_add_f32 v53, v53, v237
    s_cmp_eq_u32 s60, 0
    s_cbranch_scc1 L_e2_ok
L_e2_s3:
    s_lshl_b32 s62, -1, s61
    s_and_b32 s62, s62, s60
    s_cselect_b32 s62, s62, s60
    s_ff1_i32_b32 s89, s62
    s_add_u32 s61, s89, 1
    s_lshl_b32 s63, s89, 15
    s_add_u32 s63, s63, s32
    buffer_load_dwordx4 v[236:239], v45, s[12:15], s63 offen sc1
    s_sub_u32 s34, s34, 1
    s_and_b32 s62, s34, 31
    s_cselect_b32 s32, s64, s65
    s_cmp_lg_u32 s34, 0
    s_cbranch_scc1 L_e2
L_e2_ok:
    s_nop 1
    v_add_f32_dpp v48, v52, v52 row_ror:8 row_mask:0xf bank_mask:0xf
    v_add_f32_dpp v49, v53, v53 row_ror:8 row_mask:0xf bank_mask:0xf
    v_mov_b32 v44, v48
    v_mov_b32 v47, v49
    s_nop 0
    v_permlane16_swap_b32 v48, v44
    v_permlane16_swap_b32 v49, v47
    v_add_f32 v48, v48, v44
    v_add_f32 v49, v49, v47
    v_mov_b32 v44, v48
    v_mov_b32 v47, v49
    s_nop 0
    v_permlane32_swap_b32 v48, v44
    v_permlane32_swap_b32 v49, v47
    v_add_f32 v48, v48, v44
    v_add_f32 v49, v49, v47
    v_cvt_pk_bf16_f32 v48, v48, v48
    v_cvt_pk_bf16_f32 v49, v49, v49
    v_and_b32 v48, 0xffff0000, v48
    v_and_b32 v49, 0xffff0000, v49
    v_mul_f32 v48, v48, v56
    v_mul_f32 v49, v49, v57
    v_cvt_pk_bf16_f32 v48, v48, v48
    v_cvt_pk_bf16_f32 v49, v49, v49
    v_and_b32 v48, 0xffff0000, v48
    v_and_b32 v49, 0xffff0000, v49
    v_add_f32 v48, v48, v58
    v_add_f32 v49, v49, v59
    v_cvt_pk_bf16_f32 v48, v48, v49
    s_mov_b32 s8, s50
    s_mov_b32 s9, s51
    s_mov_b32 s10, 1024
    s_mov_b32 s11, 0x20000
    s_lshl_b32 s29, s66, 5
    v_lshlrev_b32 v46, 2, v46
    s_mov_b64 exec, 0xff
    buffer_store_dword v48, v46, s[8:11], s29 offen
    s_mov_b64 exec, -1
    s_waitcnt vmcnt(0)
    s_branch L_sback
L_hend:
    s_mov_b64 exec, -1
    s_waitcnt vmcnt(0)
L_end:
    s_endpgm
.section .rodata,"a"
.p2align 6
.amdhsa_kernel recurrent_scan__mha_block_cached__swiglu_ffn__decode_kernel
  .amdhsa_next_free_vgpr 256
  .amdhsa_next_free_sgpr 102
  .amdhsa_accum_offset 256
  .amdhsa_group_segment_fixed_size 0
  .amdhsa_kernarg_size 96
  .amdhsa_user_sgpr_count 2
  .amdhsa_user_sgpr_kernarg_segment_ptr 1
  .amdhsa_system_sgpr_workgroup_id_x 1
.end_amdhsa_kernel
```
